```python
import torch

def _softmax(x, axis=-1):
    return torch.softmax(x, dim=axis)
def _gelu(x):
    return torch.nn.functional.gelu(x, approximate="tanh")
def _silu(x):
    return torch.nn.functional.silu(x)
def _sigmoid(x):
    return torch.sigmoid(x)
def _layernorm(x, axis=-1, eps=1e-5):
    m = x.mean(dim=axis, keepdim=True)
    v = x.var(dim=axis, keepdim=True, unbiased=False)
    return (x - m) / torch.sqrt(v + eps)
def _scatter_add(tgt, idx, src, axis=0):
    return tgt.clone().index_add_(axis, idx, src)
def _segment_sum(src, seg, n):
    out = torch.zeros((n,) + src.shape[1:], dtype=src.dtype)
    return out.index_add_(0, seg, src)
def _pad(x, pw):
    flat = tuple(v for pair in reversed(pw) for v in pair)
    return torch.nn.functional.pad(x, flat)

kernel_name = 'gather_scatter__molecular_angular_gemnet__graph'

def setup_inputs():

    _w = (lambda a: (lambda t: t.to(torch.bfloat16) if t.is_floating_point() else t)(torch.as_tensor(a)))
    N, deg, De, L = 50000, 16, 16, 3
    E = N * deg
    T = E * deg
    NR = 8
    dist = torch.rand(E).to(float)
    angle = (torch.rand(T) * torch.pi).to(float)
    centers = torch.linspace(0.0, 1.0, NR).to(float)
    ang_freq = torch.arange(1, L + 1).to(float)
    return {
        "m": _w((lambda *s: torch.randn(*s, dtype=torch.bfloat16) * 0.05)(E, De)),
        "idx_in": _w((lambda lo, hi, *s: torch.randint(lo, hi, s))(0, E, T).to(torch.int64)),
        "idx_out": _w((lambda lo, hi, *s: torch.randint(lo, hi, s))(0, E, T).to(torch.int64)),
        "dist": _w(dist),
        "angle": _w(angle),
        "centers": _w(centers),
        "ang_freq": _w(ang_freq),
        "w_rbf": _w((lambda *s: torch.randn(*s, dtype=torch.bfloat16) * 0.2)(NR, De)),
        "w_sbf": _w((lambda *s: torch.randn(*s, dtype=torch.bfloat16) * 0.2)(NR * L, De)),
        "w_down": _w((lambda *s: torch.randn(*s, dtype=torch.bfloat16) * 0.2)(De, De)),
        "w_up": _w((lambda *s: torch.randn(*s, dtype=torch.bfloat16) * 0.2)(De, De)),
    }

def reference(m, idx_in, idx_out, dist, angle, centers, ang_freq, w_rbf, w_sbf, w_down, w_up):
    E, De = m.shape[0], m.shape[1]
    NR = centers.shape[0]
    L = ang_freq.shape[0]
    rbf = torch.exp(-10.0 * (dist[:, None] - centers[None, :]) ** 2)
    cbf = torch.cos(ang_freq[None, :] * angle[:, None])
    rbf_t = rbf[idx_out]
    sbf = torch.reshape(rbf_t[:, :, None] * cbf[:, None, :], (-1, NR * L))
    x = (m[idx_in] @ w_down) * (sbf @ w_sbf)
    agg = _segment_sum(x, idx_out, E)
    return m + (agg @ w_up) * (rbf @ w_rbf)
```

```asm
; @launch kernel=part_kernel grid=(256,1,1) block=(1024,1,1) lds=159808
; @launch kernel=accum_kernel grid=(256,1,1) block=(1024,1,1) lds=163840
.amdgcn_target "amdgcn-amd-amdhsa--gfx950"
.text
.globl part_kernel
.p2align 8
.type part_kernel,@function
part_kernel:
    s_cmp_ge_u32 s2, 256
    s_cbranch_scc1 A_end
    s_load_dwordx4 s[4:7], s[0:1], 8
    s_load_dwordx2 s[28:29], s[0:1], 32
    s_load_dwordx2 s[30:31], s[0:1], 104
    s_load_dwordx2 s[94:95], s[0:1], 0
    s_load_dwordx2 s[96:97], s[0:1], 24
    s_load_dwordx8 s[8:15], s[0:1], 56
    s_load_dwordx2 s[98:99], s[0:1], 40
    s_getpc_b64 s[20:21]
A_pc0:
    v_lshlrev_b32 v6, 7, v0
    v_cmp_gt_u32 vcc, B_codeend-A_pc0, v6
    s_and_saveexec_b64 s[22:23], vcc
    s_cbranch_execz A_touched
    v_mov_b32 v7, s21
    v_add_co_u32 v6, vcc, s20, v6
    s_nop 1
    v_addc_co_u32 v7, vcc, 0, v7, vcc
    global_load_dword v6, v[6:7], off
A_touched:
    s_mov_b64 exec, -1
    s_mov_b32 s32, 0
    s_mov_b32 s48, 0
    s_mov_b32 s33, 4194304
    s_mov_b32 s49, 2097152
    s_mov_b32 s34, 8388608
    s_mov_b32 s50, 4194304
    s_mov_b32 s35, 12582912
    s_mov_b32 s51, 6291456
    s_mov_b32 s36, 16777216
    s_mov_b32 s52, 8388608
    s_mov_b32 s37, 20971520
    s_mov_b32 s53, 10485760
    s_mov_b32 s38, 25165824
    s_mov_b32 s54, 12582912
    s_mov_b32 s39, 29360128
    s_mov_b32 s55, 14680064
    s_mov_b32 s40, 33554432
    s_mov_b32 s56, 16777216
    s_mov_b32 s41, 37748736
    s_mov_b32 s57, 18874368
    s_mov_b32 s42, 41943040
    s_mov_b32 s58, 20971520
    s_mov_b32 s43, 46137344
    s_mov_b32 s59, 23068672
    s_mul_i32 s60, s2, -6496
    s_add_u32 s60, s60, 25165824
    s_lshl_b32 s44, s60, 1
    v_lshlrev_b32 v1, 4, v0
    v_lshlrev_b32 v2, 3, v0
    s_getreg_b32 s47, hwreg(HW_REG_XCC_ID, 0, 4)
    s_lshr_b32 s3, s2, 3
    s_lshr_b32 s3, 0xaaaaaaaa, s3
    s_and_b32 s3, s3, 1
    s_bfe_u32 s101, s47, 0x10002
    s_xor_b32 s101, s101, s3
    s_lshl_b32 s101, s101, 9
    v_xor_b32 v4, s101, v0
    v_lshlrev_b32 v3, 5, v4
    v_lshrrev_b32 v4, 2, v4
    v_mad_u32_u24 v3, v4, 16, v3
    v_lshrrev_b32 v4, 6, v0
    v_cmp_gt_u32 vcc, 848, v0
    s_mov_b64 s[62:63], vcc
    v_readfirstlane_b32 s64, v4
    s_mov_b32 s65, 687195
    s_mov_b32 s66, -6250
    s_mov_b32 s67, 0xffff0000
    s_mov_b32 s68, 0xffff
    s_mul_i32 s69, s2, 16384
    s_mul_i32 s70, s2, 8192
    s_add_u32 s46, s44, 3392
    s_add_u32 s71, s60, 1696
    v_lshlrev_b32 v4, 2, v0
    v_lshlrev_b32 v29, 1, v0
    s_waitcnt lgkmcnt(0)
    s_cmp_ge_u32 s2, 8
    s_cbranch_scc1 A_ops_done
    s_cmp_lg_u32 s64, 15
    s_cbranch_scc1 A_ops_done
    s_load_dword s100, s[98:99], 0
    s_mov_b64 s[16:17], s[10:11]
    s_mov_b32 s18, 768
    s_mov_b32 s22, 0
    s_mov_b32 s24, 96
    s_lshl_b32 s25, s2, 5
    s_cmp_lt_u32 s2, 3
    s_cbranch_scc1 A_ops_load
    s_mov_b64 s[16:17], s[12:13]
    s_mov_b32 s18, 512
    s_mov_b32 s22, 25600000
    s_mov_b32 s24, 32
    s_andn2_b32 s25, 1, s2
    s_lshl_b32 s25, s25, 8
    s_cmp_lt_u32 s2, 5
    s_cbranch_scc1 A_ops_load
    s_mov_b64 s[16:17], s[14:15]
    s_mov_b32 s22, 0
    s_cmp_lt_u32 s2, 7
    s_cbranch_scc1 A_ops_load
    s_mov_b64 s[16:17], s[8:9]
    s_mov_b32 s18, 256
A_ops_load:
    s_and_b32 s17, s17, 0xffff
    s_mov_b32 s19, 0x20000
    s_mov_b32 s20, s94
    s_and_b32 s21, s95, 0xffff
    s_mov_b32 s23, 0x20000
    v_and_b32 v23, 30, v29
    v_and_b32 v28, 0xfc, v4
    v_bfe_u32 v25, v0, 2, 4
    v_mul_u32_u24 v25, 1600000, v25
    v_and_or_b32 v25, v1, 48, v25
    buffer_load_dword v118, v28, s[16:19], 0 offen
    buffer_load_dword v119, v28, s[16:19], 0 offen offset:256
    buffer_load_dword v120, v28, s[16:19], 0 offen offset:512
    s_mov_b32 s26, 0
    buffer_load_dwordx4 v[102:105], v25, s[20:23], s26 offen
    s_mov_b32 s26, 400000
    buffer_load_dwordx4 v[106:109], v25, s[20:23], s26 offen
    s_mov_b32 s26, 800000
    buffer_load_dwordx4 v[110:113], v25, s[20:23], s26 offen
    s_mov_b32 s26, 1200000
    buffer_load_dwordx4 v[114:117], v25, s[20:23], s26 offen
    buffer_load_ushort v94, v23, s[16:19], s25 offen
    s_add_u32 s25, s25, s24
    buffer_load_ushort v95, v23, s[16:19], s25 offen
    s_add_u32 s25, s25, s24
    buffer_load_ushort v96, v23, s[16:19], s25 offen
    s_add_u32 s25, s25, s24
    buffer_load_ushort v97, v23, s[16:19], s25 offen
    s_add_u32 s25, s25, s24
    buffer_load_ushort v98, v23, s[16:19], s25 offen
    s_add_u32 s25, s25, s24
    buffer_load_ushort v99, v23, s[16:19], s25 offen
    s_add_u32 s25, s25, s24
    buffer_load_ushort v100, v23, s[16:19], s25 offen
    s_add_u32 s25, s25, s24
    buffer_load_ushort v101, v23, s[16:19], s25 offen
    s_add_u32 s25, s25, s24
A_ops_done:
    s_add_u32 s8, s4, s69
    s_addc_u32 s9, s5, 0
    s_and_b32 s9, s9, 0xffff
    s_mov_b32 s10, s46
    s_mov_b32 s11, 0x20000
    s_add_u32 s12, s6, s69
    s_addc_u32 s13, s7, 0
    s_and_b32 s13, s13, 0xffff
    s_mov_b32 s14, s46
    s_mov_b32 s15, 0x20000
    buffer_load_dword v126, v4, s[8:11], s44 offen nt
    buffer_load_dword v127, v4, s[12:15], s44 offen nt
    buffer_load_dwordx4 v[30:33], v1, s[8:11], s32 offen nt
    buffer_load_dwordx4 v[34:37], v1, s[12:15], s32 offen nt
    s_add_u32 s30, s30, 0x1fffff
    s_addc_u32 s31, s31, 0
    s_and_b32 s30, s30, 0xffe00000
    s_mul_i32 s69, s2, 21846
    s_lshr_b32 s69, s69, 16
    s_mul_i32 s61, s2, 80
    s_lshl_b32 s69, s69, 4
    s_add_u32 s61, s61, s69
    s_lshl_b32 s69, s61, 13
    s_add_u32 s20, s30, s69
    s_addc_u32 s21, s31, 0
    s_and_b32 s21, s21, 0xffff
    s_mov_b32 s22, 655360
    s_mov_b32 s23, 0x20000
    v_mov_b32 v5, 1
    s_add_u32 s16, s28, s70
    s_addc_u32 s17, s29, 0
    s_and_b32 s17, s17, 0xffff
    s_mov_b32 s18, s71
    s_mov_b32 s19, 0x20000
    s_add_u32 s24, s30, 180355072
    s_addc_u32 s25, s31, 0
    s_and_b32 s25, s25, 0xffff
    s_mov_b32 s26, 1050640
    s_mov_b32 s27, 0x20000
    s_lshl_b32 s69, s2, 2
    s_lshr_b32 s45, 0x20101010, s69
    v_mov_b32 v8, 0
    v_mov_b32 v9, 0
    v_mov_b32 v10, 0
    v_mov_b32 v11, 0
    ds_write_b128 v1, v[8:11]
    ds_write_b128 v1, v[8:11] offset:16384
    ds_write_b128 v1, v[8:11] offset:32768
    v_add_u32 v12, 0x10000, v1
    v_add_u32 v13, 0x20000, v1
    s_waitcnt lgkmcnt(0)
    s_barrier
    s_lshr_b32 s100, s101, 2
    ds_write_b128 v1, v[8:11] offset:49152
    ds_write_b128 v12, v[8:11]
    ds_write_b128 v12, v[8:11] offset:16384
    ds_write_b128 v12, v[8:11] offset:32768
    ds_write_b128 v12, v[8:11] offset:49152
    ds_write_b128 v13, v[8:11]
    ds_write_b128 v13, v[8:11] offset:16384
    s_waitcnt vmcnt(2)
    v_mul_hi_u32 v8, v127, s65
    v_mad_i32_i24 v127, v8, s66, v127
    v_subrev_u32 v9, 3180, v127
    v_alignbit_b32 v8, v8, v9, 31
    v_min_u32 v127, v127, v9
    v_lshl_or_b32 v126, v127, 20, v126
    v_bfe_u32 v9, v126, 15, 5
    v_mad_u32_u24 v8, v8, 36, v9
    v_lshlrev_b32 v127, 2, v8
    s_mov_b64 exec, s[62:63]
    ds_add_u32 v127, v5 offset:64
    s_mov_b64 exec, -1
    s_waitcnt vmcnt(1)
    buffer_load_dwordx4 v[38:41], v1, s[8:11], s33 offen nt
    s_waitcnt vmcnt(1)
    buffer_load_dwordx4 v[42:45], v1, s[12:15], s33 offen nt
    v_mul_hi_u32 v8, v34, s65
    v_mul_hi_u32 v9, v35, s65
    v_mul_hi_u32 v10, v36, s65
    v_mul_hi_u32 v11, v37, s65
    v_mad_i32_i24 v34, v8, s66, v34
    v_mad_i32_i24 v35, v9, s66, v35
    v_mad_i32_i24 v36, v10, s66, v36
    v_mad_i32_i24 v37, v11, s66, v37
    v_subrev_u32 v16, 3180, v34
    v_subrev_u32 v17, 3180, v35
    v_subrev_u32 v18, 3180, v36
    v_subrev_u32 v19, 3180, v37
    v_alignbit_b32 v8, v8, v16, 31
    v_alignbit_b32 v9, v9, v17, 31
    v_alignbit_b32 v10, v10, v18, 31
    v_alignbit_b32 v11, v11, v19, 31
    v_min_u32 v34, v34, v16
    v_min_u32 v35, v35, v17
    v_min_u32 v36, v36, v18
    v_min_u32 v37, v37, v19
    v_lshl_or_b32 v30, v34, 20, v30
    v_lshl_or_b32 v34, v36, 20, v32
    v_lshl_or_b32 v32, v35, 20, v31
    v_lshl_or_b32 v35, v37, 20, v33
    v_bfe_u32 v16, v30, 15, 5
    v_bfe_u32 v17, v32, 15, 5
    v_bfe_u32 v18, v34, 15, 5
    v_bfe_u32 v19, v35, 15, 5
    v_mad_u32_u24 v8, v8, 36, v16
    v_mad_u32_u24 v9, v9, 36, v17
    v_mad_u32_u24 v10, v10, 36, v18
    v_mad_u32_u24 v11, v11, 36, v19
    v_lshlrev_b32 v8, 2, v8
    ds_add_u32 v8, v5 offset:64
    v_lshlrev_b32 v9, 2, v9
    ds_add_u32 v9, v5 offset:64
    v_lshlrev_b32 v10, 2, v10
    ds_add_u32 v10, v5 offset:64
    v_lshlrev_b32 v11, 2, v11
    ds_add_u32 v11, v5 offset:64
    v_lshl_or_b32 v31, v9, 16, v8
    v_lshl_or_b32 v33, v11, 16, v10
    s_cmp_ge_u32 s2, 8
    s_cbranch_scc1 A_ops2_done
    s_cmp_lg_u32 s64, 15
    s_cbranch_scc1 A_ops2_done
    v_mov_b32 v20, 0
    v_mov_b32 v21, 0
    v_bfe_u32 v22, v118, 7, 8
    v_bfe_u32 v23, v118, 23, 8
    v_max3_u32 v20, v20, v22, v23
    v_bfe_u32 v22, v119, 7, 8
    v_bfe_u32 v23, v119, 23, 8
    v_max3_u32 v20, v20, v22, v23
    v_bfe_u32 v22, v120, 7, 8
    v_bfe_u32 v23, v120, 23, 8
    v_max3_u32 v20, v20, v22, v23
    v_bfe_u32 v22, v102, 7, 8
    v_bfe_u32 v23, v102, 23, 8
    v_max3_u32 v21, v21, v22, v23
    v_bfe_u32 v22, v103, 7, 8
    v_bfe_u32 v23, v103, 23, 8
    v_max3_u32 v21, v21, v22, v23
    v_bfe_u32 v22, v104, 7, 8
    v_bfe_u32 v23, v104, 23, 8
    v_max3_u32 v21, v21, v22, v23
    v_bfe_u32 v22, v105, 7, 8
    v_bfe_u32 v23, v105, 23, 8
    v_max3_u32 v21, v21, v22, v23
    v_bfe_u32 v22, v106, 7, 8
    v_bfe_u32 v23, v106, 23, 8
    v_max3_u32 v21, v21, v22, v23
    v_bfe_u32 v22, v107, 7, 8
    v_bfe_u32 v23, v107, 23, 8
    v_max3_u32 v21, v21, v22, v23
    v_bfe_u32 v22, v108, 7, 8
    v_bfe_u32 v23, v108, 23, 8
    v_max3_u32 v21, v21, v22, v23
    v_bfe_u32 v22, v109, 7, 8
    v_bfe_u32 v23, v109, 23, 8
    v_max3_u32 v21, v21, v22, v23
    v_bfe_u32 v22, v110, 7, 8
    v_bfe_u32 v23, v110, 23, 8
    v_max3_u32 v21, v21, v22, v23
    v_bfe_u32 v22, v111, 7, 8
    v_bfe_u32 v23, v111, 23, 8
    v_max3_u32 v21, v21, v22, v23
    v_bfe_u32 v22, v112, 7, 8
    v_bfe_u32 v23, v112, 23, 8
    v_max3_u32 v21, v21, v22, v23
    v_bfe_u32 v22, v113, 7, 8
    v_bfe_u32 v23, v113, 23, 8
    v_max3_u32 v21, v21, v22, v23
    v_bfe_u32 v22, v114, 7, 8
    v_bfe_u32 v23, v114, 23, 8
    v_max3_u32 v21, v21, v22, v23
    v_bfe_u32 v22, v115, 7, 8
    v_bfe_u32 v23, v115, 23, 8
    v_max3_u32 v21, v21, v22, v23
    v_bfe_u32 v22, v116, 7, 8
    v_bfe_u32 v23, v116, 23, 8
    v_max3_u32 v21, v21, v22, v23
    v_bfe_u32 v22, v117, 7, 8
    v_bfe_u32 v23, v117, 23, 8
    v_max3_u32 v21, v21, v22, v23
    s_nop 1
    v_max_u32_dpp v20, v20, v20 row_shr:1 row_mask:0xf bank_mask:0xf bound_ctrl:1
    s_nop 1
    v_max_u32_dpp v20, v20, v20 row_shr:2 row_mask:0xf bank_mask:0xf bound_ctrl:1
    s_nop 1
    v_max_u32_dpp v20, v20, v20 row_shr:4 row_mask:0xf bank_mask:0xf bound_ctrl:1
    s_nop 1
    v_max_u32_dpp v20, v20, v20 row_shr:8 row_mask:0xf bank_mask:0xf bound_ctrl:1
    s_nop 1
    v_max_u32_dpp v20, v20, v20 row_bcast:15 row_mask:0xa bank_mask:0xf
    s_nop 1
    v_max_u32_dpp v20, v20, v20 row_bcast:31 row_mask:0xc bank_mask:0xf
    v_sub_u32 v21, 0, v21
    v_and_b32 v21, 0xff, v21
    s_nop 1
    v_max_u32_dpp v21, v21, v21 row_shr:1 row_mask:0xf bank_mask:0xf bound_ctrl:1
    s_nop 1
    v_max_u32_dpp v21, v21, v21 row_shr:2 row_mask:0xf bank_mask:0xf bound_ctrl:1
    s_nop 1
    v_max_u32_dpp v21, v21, v21 row_shr:4 row_mask:0xf bank_mask:0xf bound_ctrl:1
    s_nop 1
    v_max_u32_dpp v21, v21, v21 row_shr:8 row_mask:0xf bank_mask:0xf bound_ctrl:1
    s_nop 1
    v_max_u32_dpp v21, v21, v21 row_bcast:15 row_mask:0xa bank_mask:0xf
    s_nop 1
    v_max_u32_dpp v21, v21, v21 row_bcast:31 row_mask:0xc bank_mask:0xf
    v_readlane_b32 s69, v20, 63
    v_readlane_b32 s70, v21, 63
    s_sub_u32 s70, 0, s70
    s_and_b32 s70, s70, 0xff
    s_add_u32 s69, s69, s70
    v_mov_b32 v24, s69
    s_sub_i32 s70, 140, s69
    s_cmp_eq_u32 s2, 1
    s_addc_u32 s70, s70, 0
    s_sub_i32 s69, 226, s69
    s_sub_u32 s71, s2, 3
    s_cmp_lt_u32 s71, 2
    s_cselect_b32 s69, s69, s70
    v_lshlrev_b32 v94, 16, v94
    v_ldexp_f32 v94, v94, s69
    v_lshlrev_b32 v95, 16, v95
    v_ldexp_f32 v95, v95, s69
    v_lshlrev_b32 v96, 16, v96
    v_ldexp_f32 v96, v96, s69
    v_lshlrev_b32 v97, 16, v97
    v_ldexp_f32 v97, v97, s69
    v_lshlrev_b32 v98, 16, v98
    v_ldexp_f32 v98, v98, s69
    v_lshlrev_b32 v99, 16, v99
    v_ldexp_f32 v99, v99, s69
    v_lshlrev_b32 v100, 16, v100
    v_ldexp_f32 v100, v100, s69
    v_lshlrev_b32 v101, 16, v101
    v_ldexp_f32 v101, v101, s69
    s_cbranch_scc1 A_ops_bf16
    v_cvt_pk_f16_f32 v20, v94, v95
    v_cvt_pk_f16_f32 v21, v96, v97
    v_cvt_pk_f16_f32 v22, v98, v99
    v_cvt_pk_f16_f32 v23, v100, v101
    s_branch A_ops_store
A_ops_bf16:
    v_cvt_pk_bf16_f32 v20, v94, v95
    v_cvt_pk_bf16_f32 v21, v96, v97
    v_cvt_pk_bf16_f32 v22, v98, v99
    v_cvt_pk_bf16_f32 v23, v100, v101
A_ops_store:
    s_lshl_b32 s69, s2, 8
    s_add_u32 s69, s69, 1048576
    s_lshr_b32 s70, s2, 1
    s_lshl_b32 s70, s70, 2
    s_add_u32 s70, s70, 1050624
    v_and_b32 v25, 0x3f0, v1
    s_mov_b64 exec, 0xffff
    buffer_store_dwordx4 v[20:23], v25, s[24:27], s69 offen sc1
    s_mov_b64 exec, -1
    s_bitcmp0_b32 s2, 0
    s_cbranch_scc1 A_ops2_done
    s_mov_b64 exec, 1
    buffer_store_dword v24, v25, s[24:27], s70 offen sc1
    s_mov_b64 exec, -1
A_ops2_done:
    s_waitcnt vmcnt(1)
    s_bitcmp0_b32 5, s47
    s_cbranch_scc1 A_sh412
    s_waitcnt vmcnt(0)
A_sh412:
    buffer_load_dwordx4 v[46:49], v1, s[8:11], s34 offen nt
    s_waitcnt vmcnt(1)
    s_bitcmp0_b32 5, s47
    s_cbranch_scc1 A_sh418
    s_waitcnt vmcnt(0)
A_sh418:
    buffer_load_dwordx4 v[50:53], v1, s[12:15], s34 offen nt
    v_mul_hi_u32 v12, v42, s65
    v_mul_hi_u32 v13, v43, s65
    v_mul_hi_u32 v14, v44, s65
    v_mul_hi_u32 v15, v45, s65
    v_mad_i32_i24 v42, v12, s66, v42
    v_mad_i32_i24 v43, v13, s66, v43
    v_mad_i32_i24 v44, v14, s66, v44
    v_mad_i32_i24 v45, v15, s66, v45
    v_subrev_u32 v16, 3180, v42
    v_subrev_u32 v17, 3180, v43
    v_subrev_u32 v18, 3180, v44
    v_subrev_u32 v19, 3180, v45
    v_alignbit_b32 v12, v12, v16, 31
    v_alignbit_b32 v13, v13, v17, 31
    v_alignbit_b32 v14, v14, v18, 31
    v_alignbit_b32 v15, v15, v19, 31
    v_min_u32 v42, v42, v16
    v_min_u32 v43, v43, v17
    v_min_u32 v44, v44, v18
    v_min_u32 v45, v45, v19
    v_lshl_or_b32 v38, v42, 20, v38
    v_lshl_or_b32 v42, v44, 20, v40
    v_lshl_or_b32 v40, v43, 20, v39
    v_lshl_or_b32 v43, v45, 20, v41
    v_bfe_u32 v16, v38, 15, 5
    v_bfe_u32 v17, v40, 15, 5
    v_bfe_u32 v18, v42, 15, 5
    v_bfe_u32 v19, v43, 15, 5
    v_mad_u32_u24 v12, v12, 36, v16
    v_mad_u32_u24 v13, v13, 36, v17
    v_mad_u32_u24 v14, v14, 36, v18
    v_mad_u32_u24 v15, v15, 36, v19
    v_lshlrev_b32 v12, 2, v12
    ds_add_u32 v12, v5 offset:64
    v_lshlrev_b32 v13, 2, v13
    ds_add_u32 v13, v5 offset:64
    v_lshlrev_b32 v14, 2, v14
    ds_add_u32 v14, v5 offset:64
    v_lshlrev_b32 v15, 2, v15
    ds_add_u32 v15, v5 offset:64
    v_lshl_or_b32 v39, v13, 16, v12
    v_lshl_or_b32 v41, v15, 16, v14
    s_waitcnt vmcnt(1)
    s_bitcmp0_b32 80, s47
    s_cbranch_scc1 A_sh466
    s_waitcnt vmcnt(0)
A_sh466:
    buffer_load_dwordx4 v[54:57], v1, s[8:11], s35 offen nt
    s_waitcnt vmcnt(1)
    s_bitcmp0_b32 80, s47
    s_cbranch_scc1 A_sh472
    s_waitcnt vmcnt(0)
A_sh472:
    buffer_load_dwordx4 v[58:61], v1, s[12:15], s35 offen nt
    v_mul_hi_u32 v8, v50, s65
    v_mul_hi_u32 v9, v51, s65
    v_mul_hi_u32 v10, v52, s65
    v_mul_hi_u32 v11, v53, s65
    v_mad_i32_i24 v50, v8, s66, v50
    v_mad_i32_i24 v51, v9, s66, v51
    v_mad_i32_i24 v52, v10, s66, v52
    v_mad_i32_i24 v53, v11, s66, v53
    v_subrev_u32 v16, 3180, v50
    v_subrev_u32 v17, 3180, v51
    v_subrev_u32 v18, 3180, v52
    v_subrev_u32 v19, 3180, v53
    v_alignbit_b32 v8, v8, v16, 31
    v_alignbit_b32 v9, v9, v17, 31
    v_alignbit_b32 v10, v10, v18, 31
    v_alignbit_b32 v11, v11, v19, 31
    v_min_u32 v50, v50, v16
    v_min_u32 v51, v51, v17
    v_min_u32 v52, v52, v18
    v_min_u32 v53, v53, v19
    v_lshl_or_b32 v46, v50, 20, v46
    v_lshl_or_b32 v50, v52, 20, v48
    v_lshl_or_b32 v48, v51, 20, v47
    v_lshl_or_b32 v51, v53, 20, v49
    v_bfe_u32 v16, v46, 15, 5
    v_bfe_u32 v17, v48, 15, 5
    v_bfe_u32 v18, v50, 15, 5
    v_bfe_u32 v19, v51, 15, 5
    v_mad_u32_u24 v8, v8, 36, v16
    v_mad_u32_u24 v9, v9, 36, v17
    v_mad_u32_u24 v10, v10, 36, v18
    v_mad_u32_u24 v11, v11, 36, v19
    v_lshlrev_b32 v8, 2, v8
    ds_add_u32 v8, v5 offset:64
    v_lshlrev_b32 v9, 2, v9
    ds_add_u32 v9, v5 offset:64
    v_lshlrev_b32 v10, 2, v10
    ds_add_u32 v10, v5 offset:64
    v_lshlrev_b32 v11, 2, v11
    ds_add_u32 v11, v5 offset:64
    v_lshl_or_b32 v47, v9, 16, v8
    v_lshl_or_b32 v49, v11, 16, v10
    s_waitcnt vmcnt(1)
    s_bitcmp0_b32 15, s47
    s_cbranch_scc1 A_sh520
    s_waitcnt vmcnt(0)
A_sh520:
    buffer_load_dwordx4 v[62:65], v1, s[8:11], s36 offen nt
    s_waitcnt vmcnt(1)
    s_bitcmp0_b32 15, s47
    s_cbranch_scc1 A_sh526
    s_waitcnt vmcnt(0)
A_sh526:
    buffer_load_dwordx4 v[66:69], v1, s[12:15], s36 offen nt
    v_mul_hi_u32 v12, v58, s65
    v_mul_hi_u32 v13, v59, s65
    v_mul_hi_u32 v14, v60, s65
    v_mul_hi_u32 v15, v61, s65
    v_mad_i32_i24 v58, v12, s66, v58
    v_mad_i32_i24 v59, v13, s66, v59
    v_mad_i32_i24 v60, v14, s66, v60
    v_mad_i32_i24 v61, v15, s66, v61
    v_subrev_u32 v16, 3180, v58
    v_subrev_u32 v17, 3180, v59
    v_subrev_u32 v18, 3180, v60
    v_subrev_u32 v19, 3180, v61
    v_alignbit_b32 v12, v12, v16, 31
    v_alignbit_b32 v13, v13, v17, 31
    v_alignbit_b32 v14, v14, v18, 31
    v_alignbit_b32 v15, v15, v19, 31
    v_min_u32 v58, v58, v16
    v_min_u32 v59, v59, v17
    v_min_u32 v60, v60, v18
    v_min_u32 v61, v61, v19
    v_lshl_or_b32 v54, v58, 20, v54
    v_lshl_or_b32 v58, v60, 20, v56
    v_lshl_or_b32 v56, v59, 20, v55
    v_lshl_or_b32 v59, v61, 20, v57
    v_bfe_u32 v16, v54, 15, 5
    v_bfe_u32 v17, v56, 15, 5
    v_bfe_u32 v18, v58, 15, 5
    v_bfe_u32 v19, v59, 15, 5
    v_mad_u32_u24 v12, v12, 36, v16
    v_mad_u32_u24 v13, v13, 36, v17
    v_mad_u32_u24 v14, v14, 36, v18
    v_mad_u32_u24 v15, v15, 36, v19
    v_lshlrev_b32 v12, 2, v12
    ds_add_u32 v12, v5 offset:64
    v_lshlrev_b32 v13, 2, v13
    ds_add_u32 v13, v5 offset:64
    v_lshlrev_b32 v14, 2, v14
    ds_add_u32 v14, v5 offset:64
    v_lshlrev_b32 v15, 2, v15
    ds_add_u32 v15, v5 offset:64
    v_lshl_or_b32 v55, v13, 16, v12
    v_lshl_or_b32 v57, v15, 16, v14
    s_waitcnt vmcnt(1)
    buffer_load_dwordx4 v[70:73], v1, s[8:11], s37 offen nt
    s_waitcnt vmcnt(1)
    buffer_load_dwordx4 v[74:77], v1, s[12:15], s37 offen nt
    v_mul_hi_u32 v8, v66, s65
    v_mul_hi_u32 v9, v67, s65
    v_mul_hi_u32 v10, v68, s65
    v_mul_hi_u32 v11, v69, s65
    v_mad_i32_i24 v66, v8, s66, v66
    v_mad_i32_i24 v67, v9, s66, v67
    v_mad_i32_i24 v68, v10, s66, v68
    v_mad_i32_i24 v69, v11, s66, v69
    v_subrev_u32 v16, 3180, v66
    v_subrev_u32 v17, 3180, v67
    v_subrev_u32 v18, 3180, v68
    v_subrev_u32 v19, 3180, v69
    v_alignbit_b32 v8, v8, v16, 31
    v_alignbit_b32 v9, v9, v17, 31
    v_alignbit_b32 v10, v10, v18, 31
    v_alignbit_b32 v11, v11, v19, 31
    v_min_u32 v66, v66, v16
    v_min_u32 v67, v67, v17
    v_min_u32 v68, v68, v18
    v_min_u32 v69, v69, v19
    v_lshl_or_b32 v62, v66, 20, v62
    v_lshl_or_b32 v66, v68, 20, v64
    v_lshl_or_b32 v64, v67, 20, v63
    v_lshl_or_b32 v67, v69, 20, v65
    v_bfe_u32 v16, v62, 15, 5
    v_bfe_u32 v17, v64, 15, 5
    v_bfe_u32 v18, v66, 15, 5
    v_bfe_u32 v19, v67, 15, 5
    v_mad_u32_u24 v8, v8, 36, v16
    v_mad_u32_u24 v9, v9, 36, v17
    v_mad_u32_u24 v10, v10, 36, v18
    v_mad_u32_u24 v11, v11, 36, v19
    v_lshlrev_b32 v8, 2, v8
    ds_add_u32 v8, v5 offset:64
    v_lshlrev_b32 v9, 2, v9
    ds_add_u32 v9, v5 offset:64
    v_lshlrev_b32 v10, 2, v10
    ds_add_u32 v10, v5 offset:64
    v_lshlrev_b32 v11, 2, v11
    ds_add_u32 v11, v5 offset:64
    v_lshl_or_b32 v63, v9, 16, v8
    v_lshl_or_b32 v65, v11, 16, v10
    s_waitcnt vmcnt(1)
    s_bitcmp0_b32 245, s47
    s_cbranch_scc1 A_sh620
    s_waitcnt vmcnt(0)
A_sh620:
    buffer_load_dwordx4 v[78:81], v1, s[8:11], s38 offen nt
    s_waitcnt vmcnt(1)
    s_bitcmp0_b32 245, s47
    s_cbranch_scc1 A_sh626
    s_waitcnt vmcnt(0)
A_sh626:
    buffer_load_dwordx4 v[82:85], v1, s[12:15], s38 offen nt
    v_mul_hi_u32 v12, v74, s65
    v_mul_hi_u32 v13, v75, s65
    v_mul_hi_u32 v14, v76, s65
    v_mul_hi_u32 v15, v77, s65
    v_mad_i32_i24 v74, v12, s66, v74
    v_mad_i32_i24 v75, v13, s66, v75
    v_mad_i32_i24 v76, v14, s66, v76
    v_mad_i32_i24 v77, v15, s66, v77
    v_subrev_u32 v16, 3180, v74
    v_subrev_u32 v17, 3180, v75
    v_subrev_u32 v18, 3180, v76
    v_subrev_u32 v19, 3180, v77
    v_alignbit_b32 v12, v12, v16, 31
    v_alignbit_b32 v13, v13, v17, 31
    v_alignbit_b32 v14, v14, v18, 31
    v_alignbit_b32 v15, v15, v19, 31
    v_min_u32 v74, v74, v16
    v_min_u32 v75, v75, v17
    v_min_u32 v76, v76, v18
    v_min_u32 v77, v77, v19
    v_lshl_or_b32 v70, v74, 20, v70
    v_lshl_or_b32 v74, v76, 20, v72
    v_lshl_or_b32 v72, v75, 20, v71
    v_lshl_or_b32 v75, v77, 20, v73
    v_bfe_u32 v16, v70, 15, 5
    v_bfe_u32 v17, v72, 15, 5
    v_bfe_u32 v18, v74, 15, 5
    v_bfe_u32 v19, v75, 15, 5
    v_mad_u32_u24 v12, v12, 36, v16
    v_mad_u32_u24 v13, v13, 36, v17
    v_mad_u32_u24 v14, v14, 36, v18
    v_mad_u32_u24 v15, v15, 36, v19
    v_lshlrev_b32 v12, 2, v12
    ds_add_u32 v12, v5 offset:64
    v_lshlrev_b32 v13, 2, v13
    ds_add_u32 v13, v5 offset:64
    v_lshlrev_b32 v14, 2, v14
    ds_add_u32 v14, v5 offset:64
    v_lshlrev_b32 v15, 2, v15
    ds_add_u32 v15, v5 offset:64
    v_lshl_or_b32 v71, v13, 16, v12
    v_lshl_or_b32 v73, v15, 16, v14
    s_waitcnt vmcnt(1)
    buffer_load_dwordx4 v[86:89], v1, s[8:11], s39 offen nt
    s_waitcnt vmcnt(1)
    buffer_load_dwordx4 v[90:93], v1, s[12:15], s39 offen nt
    v_mul_hi_u32 v8, v82, s65
    v_mul_hi_u32 v9, v83, s65
    v_mul_hi_u32 v10, v84, s65
    v_mul_hi_u32 v11, v85, s65
    v_mad_i32_i24 v82, v8, s66, v82
    v_mad_i32_i24 v83, v9, s66, v83
    v_mad_i32_i24 v84, v10, s66, v84
    v_mad_i32_i24 v85, v11, s66, v85
    v_subrev_u32 v16, 3180, v82
    v_subrev_u32 v17, 3180, v83
    v_subrev_u32 v18, 3180, v84
    v_subrev_u32 v19, 3180, v85
    v_alignbit_b32 v8, v8, v16, 31
    v_alignbit_b32 v9, v9, v17, 31
    v_alignbit_b32 v10, v10, v18, 31
    v_alignbit_b32 v11, v11, v19, 31
    v_min_u32 v82, v82, v16
    v_min_u32 v83, v83, v17
    v_min_u32 v84, v84, v18
    v_min_u32 v85, v85, v19
    v_lshl_or_b32 v78, v82, 20, v78
    v_lshl_or_b32 v82, v84, 20, v80
    v_lshl_or_b32 v80, v83, 20, v79
    v_lshl_or_b32 v83, v85, 20, v81
    v_bfe_u32 v16, v78, 15, 5
    v_bfe_u32 v17, v80, 15, 5
    v_bfe_u32 v18, v82, 15, 5
    v_bfe_u32 v19, v83, 15, 5
    v_mad_u32_u24 v8, v8, 36, v16
    v_mad_u32_u24 v9, v9, 36, v17
    v_mad_u32_u24 v10, v10, 36, v18
    v_mad_u32_u24 v11, v11, 36, v19
    v_lshlrev_b32 v8, 2, v8
    ds_add_u32 v8, v5 offset:64
    v_lshlrev_b32 v9, 2, v9
    ds_add_u32 v9, v5 offset:64
    v_lshlrev_b32 v10, 2, v10
    ds_add_u32 v10, v5 offset:64
    v_lshlrev_b32 v11, 2, v11
    ds_add_u32 v11, v5 offset:64
    v_lshl_or_b32 v79, v9, 16, v8
    v_lshl_or_b32 v81, v11, 16, v10
    s_waitcnt vmcnt(1)
    s_bitcmp0_b32 15, s47
    s_cbranch_scc1 A_sh720
    s_waitcnt vmcnt(0)
A_sh720:
    buffer_load_dwordx4 v[94:97], v1, s[8:11], s40 offen nt
    s_waitcnt vmcnt(1)
    s_bitcmp0_b32 15, s47
    s_cbranch_scc1 A_sh726
    s_waitcnt vmcnt(0)
A_sh726:
    buffer_load_dwordx4 v[98:101], v1, s[12:15], s40 offen nt
    v_mul_hi_u32 v12, v90, s65
    v_mul_hi_u32 v13, v91, s65
    v_mul_hi_u32 v14, v92, s65
    v_mul_hi_u32 v15, v93, s65
    v_mad_i32_i24 v90, v12, s66, v90
    v_mad_i32_i24 v91, v13, s66, v91
    v_mad_i32_i24 v92, v14, s66, v92
    v_mad_i32_i24 v93, v15, s66, v93
    v_subrev_u32 v16, 3180, v90
    v_subrev_u32 v17, 3180, v91
    v_subrev_u32 v18, 3180, v92
    v_subrev_u32 v19, 3180, v93
    v_alignbit_b32 v12, v12, v16, 31
    v_alignbit_b32 v13, v13, v17, 31
    v_alignbit_b32 v14, v14, v18, 31
    v_alignbit_b32 v15, v15, v19, 31
    v_min_u32 v90, v90, v16
    v_min_u32 v91, v91, v17
    v_min_u32 v92, v92, v18
    v_min_u32 v93, v93, v19
    v_lshl_or_b32 v86, v90, 20, v86
    v_lshl_or_b32 v90, v92, 20, v88
    v_lshl_or_b32 v88, v91, 20, v87
    v_lshl_or_b32 v91, v93, 20, v89
    v_bfe_u32 v16, v86, 15, 5
    v_bfe_u32 v17, v88, 15, 5
    v_bfe_u32 v18, v90, 15, 5
    v_bfe_u32 v19, v91, 15, 5
    v_mad_u32_u24 v12, v12, 36, v16
    v_mad_u32_u24 v13, v13, 36, v17
    v_mad_u32_u24 v14, v14, 36, v18
    v_mad_u32_u24 v15, v15, 36, v19
    v_lshlrev_b32 v12, 2, v12
    ds_add_u32 v12, v5 offset:64
    v_lshlrev_b32 v13, 2, v13
    ds_add_u32 v13, v5 offset:64
    v_lshlrev_b32 v14, 2, v14
    ds_add_u32 v14, v5 offset:64
    v_lshlrev_b32 v15, 2, v15
    ds_add_u32 v15, v5 offset:64
    v_lshl_or_b32 v87, v13, 16, v12
    v_lshl_or_b32 v89, v15, 16, v14
    s_waitcnt vmcnt(1)
    s_bitcmp0_b32 80, s47
    s_cbranch_scc1 A_sh774
    s_waitcnt vmcnt(0)
A_sh774:
    buffer_load_dwordx4 v[102:105], v1, s[8:11], s41 offen nt
    s_waitcnt vmcnt(1)
    s_bitcmp0_b32 80, s47
    s_cbranch_scc1 A_sh780
    s_waitcnt vmcnt(0)
A_sh780:
    buffer_load_dwordx4 v[106:109], v1, s[12:15], s41 offen nt
    v_mul_hi_u32 v8, v98, s65
    v_mul_hi_u32 v9, v99, s65
    v_mul_hi_u32 v10, v100, s65
    v_mul_hi_u32 v11, v101, s65
    v_mad_i32_i24 v98, v8, s66, v98
    v_mad_i32_i24 v99, v9, s66, v99
    v_mad_i32_i24 v100, v10, s66, v100
    v_mad_i32_i24 v101, v11, s66, v101
    v_subrev_u32 v16, 3180, v98
    v_subrev_u32 v17, 3180, v99
    v_subrev_u32 v18, 3180, v100
    v_subrev_u32 v19, 3180, v101
    v_alignbit_b32 v8, v8, v16, 31
    v_alignbit_b32 v9, v9, v17, 31
    v_alignbit_b32 v10, v10, v18, 31
    v_alignbit_b32 v11, v11, v19, 31
    v_min_u32 v98, v98, v16
    v_min_u32 v99, v99, v17
    v_min_u32 v100, v100, v18
    v_min_u32 v101, v101, v19
    v_lshl_or_b32 v94, v98, 20, v94
    v_lshl_or_b32 v98, v100, 20, v96
    v_lshl_or_b32 v96, v99, 20, v95
    v_lshl_or_b32 v99, v101, 20, v97
    v_bfe_u32 v16, v94, 15, 5
    v_bfe_u32 v17, v96, 15, 5
    v_bfe_u32 v18, v98, 15, 5
    v_bfe_u32 v19, v99, 15, 5
    v_mad_u32_u24 v8, v8, 36, v16
    v_mad_u32_u24 v9, v9, 36, v17
    v_mad_u32_u24 v10, v10, 36, v18
    v_mad_u32_u24 v11, v11, 36, v19
    v_lshlrev_b32 v8, 2, v8
    ds_add_u32 v8, v5 offset:64
    v_lshlrev_b32 v9, 2, v9
    ds_add_u32 v9, v5 offset:64
    v_lshlrev_b32 v10, 2, v10
    ds_add_u32 v10, v5 offset:64
    v_lshlrev_b32 v11, 2, v11
    ds_add_u32 v11, v5 offset:64
    v_lshl_or_b32 v95, v9, 16, v8
    v_lshl_or_b32 v97, v11, 16, v10
    s_waitcnt vmcnt(1)
    s_bitcmp0_b32 5, s47
    s_cbranch_scc1 A_sh828
    s_waitcnt vmcnt(0)
A_sh828:
    buffer_load_dwordx4 v[110:113], v1, s[8:11], s42 offen nt
    s_waitcnt vmcnt(1)
    s_bitcmp0_b32 5, s47
    s_cbranch_scc1 A_sh834
    s_waitcnt vmcnt(0)
A_sh834:
    buffer_load_dwordx4 v[114:117], v1, s[12:15], s42 offen nt
    v_mul_hi_u32 v12, v106, s65
    v_mul_hi_u32 v13, v107, s65
    v_mul_hi_u32 v14, v108, s65
    v_mul_hi_u32 v15, v109, s65
    v_mad_i32_i24 v106, v12, s66, v106
    v_mad_i32_i24 v107, v13, s66, v107
    v_mad_i32_i24 v108, v14, s66, v108
    v_mad_i32_i24 v109, v15, s66, v109
    v_subrev_u32 v16, 3180, v106
    v_subrev_u32 v17, 3180, v107
    v_subrev_u32 v18, 3180, v108
    v_subrev_u32 v19, 3180, v109
    v_alignbit_b32 v12, v12, v16, 31
    v_alignbit_b32 v13, v13, v17, 31
    v_alignbit_b32 v14, v14, v18, 31
    v_alignbit_b32 v15, v15, v19, 31
    v_min_u32 v106, v106, v16
    v_min_u32 v107, v107, v17
    v_min_u32 v108, v108, v18
    v_min_u32 v109, v109, v19
    v_lshl_or_b32 v102, v106, 20, v102
    v_lshl_or_b32 v106, v108, 20, v104
    v_lshl_or_b32 v104, v107, 20, v103
    v_lshl_or_b32 v107, v109, 20, v105
    v_bfe_u32 v16, v102, 15, 5
    v_bfe_u32 v17, v104, 15, 5
    v_bfe_u32 v18, v106, 15, 5
    v_bfe_u32 v19, v107, 15, 5
    v_mad_u32_u24 v12, v12, 36, v16
    v_mad_u32_u24 v13, v13, 36, v17
    v_mad_u32_u24 v14, v14, 36, v18
    v_mad_u32_u24 v15, v15, 36, v19
    v_lshlrev_b32 v12, 2, v12
    ds_add_u32 v12, v5 offset:64
    v_lshlrev_b32 v13, 2, v13
    ds_add_u32 v13, v5 offset:64
    v_lshlrev_b32 v14, 2, v14
    ds_add_u32 v14, v5 offset:64
    v_lshlrev_b32 v15, 2, v15
    ds_add_u32 v15, v5 offset:64
    v_lshl_or_b32 v103, v13, 16, v12
    v_lshl_or_b32 v105, v15, 16, v14
    s_waitcnt vmcnt(1)
    buffer_load_dwordx4 v[118:121], v1, s[8:11], s43 offen nt
    s_waitcnt vmcnt(1)
    buffer_load_dwordx4 v[122:125], v1, s[12:15], s43 offen nt
    v_mul_hi_u32 v8, v114, s65
    v_mul_hi_u32 v9, v115, s65
    v_mul_hi_u32 v10, v116, s65
    v_mul_hi_u32 v11, v117, s65
    v_mad_i32_i24 v114, v8, s66, v114
    v_mad_i32_i24 v115, v9, s66, v115
    v_mad_i32_i24 v116, v10, s66, v116
    v_mad_i32_i24 v117, v11, s66, v117
    v_subrev_u32 v16, 3180, v114
    v_subrev_u32 v17, 3180, v115
    v_subrev_u32 v18, 3180, v116
    v_subrev_u32 v19, 3180, v117
    v_alignbit_b32 v8, v8, v16, 31
    v_alignbit_b32 v9, v9, v17, 31
    v_alignbit_b32 v10, v10, v18, 31
    v_alignbit_b32 v11, v11, v19, 31
    v_min_u32 v114, v114, v16
    v_min_u32 v115, v115, v17
    v_min_u32 v116, v116, v18
    v_min_u32 v117, v117, v19
    v_lshl_or_b32 v110, v114, 20, v110
    v_lshl_or_b32 v114, v116, 20, v112
    v_lshl_or_b32 v112, v115, 20, v111
    v_lshl_or_b32 v115, v117, 20, v113
    v_bfe_u32 v16, v110, 15, 5
    v_bfe_u32 v17, v112, 15, 5
    v_bfe_u32 v18, v114, 15, 5
    v_bfe_u32 v19, v115, 15, 5
    v_mad_u32_u24 v8, v8, 36, v16
    v_mad_u32_u24 v9, v9, 36, v17
    v_mad_u32_u24 v10, v10, 36, v18
    v_mad_u32_u24 v11, v11, 36, v19
    v_lshlrev_b32 v8, 2, v8
    ds_add_u32 v8, v5 offset:64
    v_lshlrev_b32 v9, 2, v9
    ds_add_u32 v9, v5 offset:64
    v_lshlrev_b32 v10, 2, v10
    ds_add_u32 v10, v5 offset:64
    v_lshlrev_b32 v11, 2, v11
    ds_add_u32 v11, v5 offset:64
    v_lshl_or_b32 v111, v9, 16, v8
    v_lshl_or_b32 v113, v11, 16, v10
    s_waitcnt vmcnt(1)
    buffer_load_ushort v28, v29, s[16:19], s60 offen nt
    buffer_load_dwordx2 v[36:37], v2, s[16:19], s48 offen nt
    s_waitcnt vmcnt(2)
    buffer_load_dwordx2 v[44:45], v2, s[16:19], s49 offen nt
    buffer_load_dwordx2 v[52:53], v2, s[16:19], s50 offen nt
    v_mul_hi_u32 v12, v122, s65
    v_mul_hi_u32 v13, v123, s65
    v_mul_hi_u32 v14, v124, s65
    v_mul_hi_u32 v15, v125, s65
    v_mad_i32_i24 v122, v12, s66, v122
    v_mad_i32_i24 v123, v13, s66, v123
    v_mad_i32_i24 v124, v14, s66, v124
    v_mad_i32_i24 v125, v15, s66, v125
    v_subrev_u32 v16, 3180, v122
    v_subrev_u32 v17, 3180, v123
    v_subrev_u32 v18, 3180, v124
    v_subrev_u32 v19, 3180, v125
    v_alignbit_b32 v12, v12, v16, 31
    v_alignbit_b32 v13, v13, v17, 31
    v_alignbit_b32 v14, v14, v18, 31
    v_alignbit_b32 v15, v15, v19, 31
    v_min_u32 v122, v122, v16
    v_min_u32 v123, v123, v17
    v_min_u32 v124, v124, v18
    v_min_u32 v125, v125, v19
    v_lshl_or_b32 v118, v122, 20, v118
    v_lshl_or_b32 v122, v124, 20, v120
    v_lshl_or_b32 v120, v123, 20, v119
    v_lshl_or_b32 v123, v125, 20, v121
    v_bfe_u32 v16, v118, 15, 5
    v_bfe_u32 v17, v120, 15, 5
    v_bfe_u32 v18, v122, 15, 5
    v_bfe_u32 v19, v123, 15, 5
    v_mad_u32_u24 v12, v12, 36, v16
    v_mad_u32_u24 v13, v13, 36, v17
    v_mad_u32_u24 v14, v14, 36, v18
    v_mad_u32_u24 v15, v15, 36, v19
    v_lshlrev_b32 v12, 2, v12
    ds_add_u32 v12, v5 offset:64
    v_lshlrev_b32 v13, 2, v13
    ds_add_u32 v13, v5 offset:64
    v_lshlrev_b32 v14, 2, v14
    ds_add_u32 v14, v5 offset:64
    v_lshlrev_b32 v15, 2, v15
    ds_add_u32 v15, v5 offset:64
    v_lshl_or_b32 v119, v13, 16, v12
    v_lshl_or_b32 v121, v15, 16, v14
    s_waitcnt lgkmcnt(0)
    s_barrier
    ds_read_b128 v[8:11], v3 offset:64
    ds_read_b128 v[12:15], v3 offset:80
    v_and_b32 v6, 3, v0
    s_lshl_b32 s69, s64, 2
    s_add_u32 s69, s69, 40960
    v_mov_b32 v19, s69
    v_and_b32 v17, 15, v0
    v_lshlrev_b32 v17, 2, v17
    s_waitcnt lgkmcnt(0)
    v_add_u32 v9, v8, v9
    v_add_u32 v10, v9, v10
    v_add_u32 v11, v10, v11
    v_add_u32 v12, v11, v12
    v_add_u32 v13, v12, v13
    v_add_u32 v14, v13, v14
    v_add_u32 v15, v14, v15
    s_bfe_u32 s69, s45, 0x20002
    v_cmp_eq_u32 vcc, s69, v6
    v_add_u32_dpp v7, v15, v15 quad_perm:[1,0,3,2] row_mask:0xf bank_mask:0xf
    s_mov_b32 s70, 43691
    s_bitcmp1_b32 s45, 1
    v_add_u32_dpp v7, v7, v7 quad_perm:[2,3,0,1] row_mask:0xf bank_mask:0xf
    v_add_u32 v20, 23, v7
    v_mul_u32_u24 v20, s70, v20
    v_lshrrev_b32 v20, 20, v20
    v_mul_u32_u24 v21, 24, v20
    v_sub_u32 v7, v21, v7
    v_cndmask_b32 v21, 0, v7, vcc
    v_lshl_or_b32 v7, v20, 16, v7
    v_mov_b32 v20, v15
    s_cbranch_scc1 A_hole7
    s_bitcmp1_b32 s45, 0
    v_mov_b32 v20, v11
    s_cbranch_scc1 A_hole3
    v_mov_b32 v20, v8
    v_add_u32 v8, v8, v21
    v_add_u32 v9, v9, v21
    v_add_u32 v10, v10, v21
A_hole3:
    v_add_u32 v11, v11, v21
    v_add_u32 v12, v12, v21
    v_add_u32 v13, v13, v21
    v_add_u32 v14, v14, v21
A_hole7:
    v_add_u32 v15, v15, v21
    v_mov_b32 v18, v15
    s_nop 1
    v_add_u32_dpp v18, v18, v18 row_shr:1 row_mask:0xf bank_mask:0xf bound_ctrl:1
    s_nop 1
    v_add_u32_dpp v18, v18, v18 row_shr:2 row_mask:0xf bank_mask:0xf bound_ctrl:1
    s_nop 1
    v_add_u32_dpp v18, v18, v18 row_shr:4 row_mask:0xf bank_mask:0xf bound_ctrl:1
    s_nop 1
    v_add_u32_dpp v18, v18, v18 row_shr:8 row_mask:0xf bank_mask:0xf bound_ctrl:1
    s_nop 1
    v_add_u32_dpp v18, v18, v18 row_bcast:15 row_mask:0xa bank_mask:0xf
    s_nop 1
    v_add_u32_dpp v18, v18, v18 row_bcast:31 row_mask:0xc bank_mask:0xf
    s_mov_b32 exec_lo, 0
    s_brev_b32 exec_hi, 1
    ds_write_b32 v19, v18
    s_mov_b64 exec, -1
    v_sub_u32 v18, v18, v15
    s_waitcnt lgkmcnt(0)
    s_barrier
    ds_read_b32 v19, v17 offset:40960
    s_waitcnt lgkmcnt(0)
    v_mov_b32 v17, v19
    s_nop 1
    v_add_u32_dpp v17, v17, v17 row_shr:1 row_mask:0xf bank_mask:0xf bound_ctrl:1
    s_nop 1
    v_add_u32_dpp v17, v17, v17 row_shr:2 row_mask:0xf bank_mask:0xf bound_ctrl:1
    s_nop 1
    v_add_u32_dpp v17, v17, v17 row_shr:4 row_mask:0xf bank_mask:0xf bound_ctrl:1
    s_nop 1
    v_add_u32_dpp v17, v17, v17 row_shr:8 row_mask:0xf bank_mask:0xf bound_ctrl:1
    v_sub_u32 v19, v17, v19
    v_readlane_b32 s46, v17, 15
    v_readlane_b32 s69, v19, s64
    v_readlane_b32 s101, v19, 8
    s_nop 0
    v_add_u32 v4, s69, v18
    v_add_u32 v16, v4, v15
    v_add_u32 v15, v4, v14
    v_add_u32 v14, v4, v13
    v_add_u32 v13, v4, v12
    v_add_u32 v12, v4, v11
    v_add_u32 v11, v4, v10
    v_add_u32 v10, v4, v9
    v_add_u32 v9, v4, v8
    v_mov_b32 v8, v4
    ds_write_b128 v3, v[12:15] offset:80
    ds_write_b128 v3, v[8:11] offset:64
    v_add_u32 v19, v4, v20
    v_cndmask_b32 v19, 0, v19, vcc
    v_mov_b32 v3, 524292
    s_mul_i32 s46, s46, 43691
    s_lshr_b32 s46, s46, 20
    s_mul_i32 s101, s101, 43691
    s_lshr_b32 s101, s101, 20
    s_lshr_b32 s71, s2, 3
    s_bitcmp1_b32 0x10001, s71
    s_cselect_b32 s101, 4095, s101
    v_and_b32 v20, s68, v31
    v_lshrrev_b32 v21, 16, v31
    v_and_b32 v22, s68, v33
    v_lshrrev_b32 v23, 16, v33
    v_and_b32 v24, s68, v39
    v_lshrrev_b32 v25, 16, v39
    v_and_b32 v26, s68, v41
    v_lshrrev_b32 v27, 16, v41
    s_waitcnt lgkmcnt(0)
    s_barrier
    s_cmp_lt_u32 s64, 15
    s_cbranch_scc1 A_noprobe0
    v_bfe_u32 v17, v0, 3, 1
    v_and_b32 v18, 0x1fb8, v2
    v_lshl_or_b32 v17, v17, 13, v18
    s_mov_b32 s69, 638976
    buffer_store_dwordx2 v[4:5], v17, s[20:23], s69 offen sc1
A_noprobe0:
    buffer_load_dwordx2 v[60:61], v2, s[16:19], s51 offen nt
    buffer_load_dwordx2 v[68:69], v2, s[16:19], s52 offen nt
    buffer_load_dwordx2 v[76:77], v2, s[16:19], s53 offen nt
    s_not_b64 exec, s[62:63]
    v_mov_b32 v127, 0xffff
    s_mov_b64 exec, s[62:63]
    ds_add_rtn_u32 v127, v127, v5 offset:64
    s_mov_b64 exec, -1
    ds_add_rtn_u32 v20, v20, v5 offset:64
    ds_add_rtn_u32 v21, v21, v5 offset:64
    ds_add_rtn_u32 v22, v22, v5 offset:64
    ds_add_rtn_u32 v23, v23, v5 offset:64
    ds_add_rtn_u32 v24, v24, v5 offset:64
    ds_add_rtn_u32 v25, v25, v5 offset:64
    ds_add_rtn_u32 v26, v26, v5 offset:64
    ds_add_rtn_u32 v27, v27, v5 offset:64
    v_mad_u32_u24 v8, v8, s70, v3
    v_lshrrev_b32 v8, 20, v8
    v_mad_u32_u24 v9, v9, s70, v3
    v_lshrrev_b32 v9, 20, v9
    v_mad_u32_u24 v10, v10, s70, v3
    v_lshrrev_b32 v10, 20, v10
    v_mad_u32_u24 v11, v11, s70, v3
    v_lshrrev_b32 v11, 20, v11
    v_mad_u32_u24 v12, v12, s70, v3
    v_lshrrev_b32 v12, 20, v12
    v_mad_u32_u24 v13, v13, s70, v3
    v_lshrrev_b32 v13, 20, v13
    v_mad_u32_u24 v14, v14, s70, v3
    v_lshrrev_b32 v14, 20, v14
    v_mad_u32_u24 v15, v15, s70, v3
    v_lshrrev_b32 v15, 20, v15
    v_mad_u32_u24 v16, v16, s70, v3
    v_lshrrev_b32 v16, 20, v16
    v_sub_u32 v16, v16, v15
    v_sub_u32 v15, v15, v14
    v_sub_u32 v14, v14, v13
    v_sub_u32 v13, v13, v12
    v_sub_u32 v12, v12, v11
    v_sub_u32 v11, v11, v10
    v_sub_u32 v10, v10, v9
    v_sub_u32 v9, v9, v8
    v_min_u32 v9, 2, v9
    v_bfm_b32 v9, v9, 0
    v_min_u32 v10, 2, v10
    v_bfm_b32 v10, v10, 1
    v_min_u32 v11, 2, v11
    v_bfm_b32 v11, v11, 2
    v_min_u32 v12, 2, v12
    v_bfm_b32 v12, v12, 3
    v_min_u32 v13, 2, v13
    v_bfm_b32 v13, v13, 4
    v_min_u32 v14, 2, v14
    v_bfm_b32 v14, v14, 5
    v_min_u32 v15, 2, v15
    v_bfm_b32 v15, v15, 6
    v_min_u32 v16, 2, v16
    v_bfm_b32 v16, v16, 7
    v_or3_b32 v18, v9, v10, v11
    v_or3_b32 v18, v18, v12, v13
    v_or3_b32 v18, v18, v14, v15
    v_or_b32 v18, v18, v16
    v_lshlrev_b32 v6, 3, v6
    v_lshlrev_b32 v18, v6, v18
    s_lshr_b32 s69, s64, 3
    s_cmp_eq_u32 s101, 4095
    s_cselect_b32 s69, 0, s69
    s_xor_b32 s69, s69, s3
    s_add_u32 s69, s69, s61
    s_lshl_b32 s69, s69, 12
    v_or_b32_dpp v19, v19, v19 quad_perm:[1,0,3,2] row_mask:0xf bank_mask:0xf
    v_or_b32_dpp v18, v18, v18 quad_perm:[1,0,3,2] row_mask:0xf bank_mask:0xf
    v_add_u32 v16, s69, v8
    v_or_b32_dpp v19, v19, v19 quad_perm:[2,3,0,1] row_mask:0xf bank_mask:0xf
    v_or_b32_dpp v18, v18, v18 quad_perm:[2,3,0,1] row_mask:0xf bank_mask:0xf
    v_and_b32 v12, 31, v7
    v_lshl_or_b32 v16, v12, 27, v16
    v_sub_u32 v19, v19, v4
    v_and_or_b32 v17, v7, s67, v19
    v_lshrrev_b32 v12, 16, v7
    v_bcnt_u32_b32 v13, v18, 0
    v_sub_u32 v12, v12, v13
    v_min_u32 v12, 6, v12
    v_bfm_b32 v12, v12, 26
    v_or_b32 v18, v18, v12
    v_mov_b32 v6, 0
    s_mov_b32 s98, 50331648
    s_mov_b32 s99, 50331648
    v_and_b32 v8, s68, v47
    v_lshrrev_b32 v9, 16, v47
    v_and_b32 v10, s68, v49
    v_lshrrev_b32 v11, 16, v49
    ds_add_rtn_u32 v8, v8, v5 offset:64
    ds_add_rtn_u32 v9, v9, v5 offset:64
    ds_add_rtn_u32 v10, v10, v5 offset:64
    ds_add_rtn_u32 v11, v11, v5 offset:64
    buffer_load_dwordx2 v[84:85], v2, s[16:19], s54 offen nt
    s_waitcnt lgkmcnt(8)
    v_lshl_or_b32 v31, v21, 16, v20
    v_lshl_or_b32 v33, v23, 16, v22
    v_and_b32 v20, s68, v55
    v_lshrrev_b32 v21, 16, v55
    v_and_b32 v22, s68, v57
    v_lshrrev_b32 v23, 16, v57
    ds_add_rtn_u32 v20, v20, v5 offset:64
    ds_add_rtn_u32 v21, v21, v5 offset:64
    ds_add_rtn_u32 v22, v22, v5 offset:64
    ds_add_rtn_u32 v23, v23, v5 offset:64
    buffer_load_dwordx2 v[92:93], v2, s[16:19], s55 offen nt
    s_waitcnt lgkmcnt(8)
    v_lshl_or_b32 v39, v25, 16, v24
    v_lshl_or_b32 v41, v27, 16, v26
    v_and_b32 v24, s68, v63
    v_lshrrev_b32 v25, 16, v63
    v_and_b32 v26, s68, v65
    v_lshrrev_b32 v27, 16, v65
    ds_add_rtn_u32 v24, v24, v5 offset:64
    ds_add_rtn_u32 v25, v25, v5 offset:64
    ds_add_rtn_u32 v26, v26, v5 offset:64
    ds_add_rtn_u32 v27, v27, v5 offset:64
    buffer_load_dwordx2 v[100:101], v2, s[16:19], s56 offen nt
    s_waitcnt lgkmcnt(8)
    v_lshl_or_b32 v47, v9, 16, v8
    v_lshl_or_b32 v49, v11, 16, v10
    v_and_b32 v8, s68, v71
    v_lshrrev_b32 v9, 16, v71
    v_and_b32 v10, s68, v73
    v_lshrrev_b32 v11, 16, v73
    ds_add_rtn_u32 v8, v8, v5 offset:64
    ds_add_rtn_u32 v9, v9, v5 offset:64
    ds_add_rtn_u32 v10, v10, v5 offset:64
    ds_add_rtn_u32 v11, v11, v5 offset:64
    buffer_load_dwordx2 v[108:109], v2, s[16:19], s57 offen nt
    s_waitcnt lgkmcnt(8)
    v_lshl_or_b32 v55, v21, 16, v20
    v_lshl_or_b32 v57, v23, 16, v22
    v_and_b32 v20, s68, v79
    v_lshrrev_b32 v21, 16, v79
    v_and_b32 v22, s68, v81
    v_lshrrev_b32 v23, 16, v81
    ds_add_rtn_u32 v20, v20, v5 offset:64
    ds_add_rtn_u32 v21, v21, v5 offset:64
    ds_add_rtn_u32 v22, v22, v5 offset:64
    ds_add_rtn_u32 v23, v23, v5 offset:64
    buffer_load_dwordx2 v[116:117], v2, s[16:19], s58 offen nt
    s_waitcnt lgkmcnt(8)
    v_lshl_or_b32 v63, v25, 16, v24
    v_lshl_or_b32 v65, v27, 16, v26
    v_and_b32 v24, s68, v87
    v_lshrrev_b32 v25, 16, v87
    v_and_b32 v26, s68, v89
    v_lshrrev_b32 v27, 16, v89
    ds_add_rtn_u32 v24, v24, v5 offset:64
    ds_add_rtn_u32 v25, v25, v5 offset:64
    ds_add_rtn_u32 v26, v26, v5 offset:64
    ds_add_rtn_u32 v27, v27, v5 offset:64
    buffer_load_dwordx2 v[124:125], v2, s[16:19], s59 offen nt
    s_waitcnt lgkmcnt(8)
    v_lshl_or_b32 v71, v9, 16, v8
    v_lshl_or_b32 v73, v11, 16, v10
    v_and_b32 v8, s68, v95
    v_lshrrev_b32 v9, 16, v95
    v_and_b32 v10, s68, v97
    v_lshrrev_b32 v11, 16, v97
    ds_add_rtn_u32 v8, v8, v5 offset:64
    ds_add_rtn_u32 v9, v9, v5 offset:64
    ds_add_rtn_u32 v10, v10, v5 offset:64
    ds_add_rtn_u32 v11, v11, v5 offset:64
    s_waitcnt lgkmcnt(8)
    v_lshl_or_b32 v79, v21, 16, v20
    v_lshl_or_b32 v81, v23, 16, v22
    v_and_b32 v20, s68, v103
    v_lshrrev_b32 v21, 16, v103
    v_and_b32 v22, s68, v105
    v_lshrrev_b32 v23, 16, v105
    ds_add_rtn_u32 v20, v20, v5 offset:64
    ds_add_rtn_u32 v21, v21, v5 offset:64
    ds_add_rtn_u32 v22, v22, v5 offset:64
    ds_add_rtn_u32 v23, v23, v5 offset:64
    s_waitcnt lgkmcnt(8)
    v_lshl_or_b32 v87, v25, 16, v24
    v_lshl_or_b32 v89, v27, 16, v26
    v_and_b32 v24, s68, v111
    v_lshrrev_b32 v25, 16, v111
    v_and_b32 v26, s68, v113
    v_lshrrev_b32 v27, 16, v113
    ds_add_rtn_u32 v24, v24, v5 offset:64
    ds_add_rtn_u32 v25, v25, v5 offset:64
    ds_add_rtn_u32 v26, v26, v5 offset:64
    ds_add_rtn_u32 v27, v27, v5 offset:64
    s_waitcnt lgkmcnt(8)
    v_lshl_or_b32 v95, v9, 16, v8
    v_lshl_or_b32 v97, v11, 16, v10
    v_and_b32 v8, s68, v119
    v_lshrrev_b32 v9, 16, v119
    v_and_b32 v10, s68, v121
    v_lshrrev_b32 v11, 16, v121
    ds_add_rtn_u32 v8, v8, v5 offset:64
    ds_add_rtn_u32 v9, v9, v5 offset:64
    ds_add_rtn_u32 v10, v10, v5 offset:64
    ds_add_rtn_u32 v11, v11, v5 offset:64
    s_waitcnt vmcnt(11)
    v_lshlrev_b32 v12, 16, v36
    v_and_b32 v13, 0xffff0000, v36
    v_lshlrev_b32 v14, 16, v37
    v_and_b32 v15, 0xffff0000, v37
    v_pk_mul_f32 v[12:13], v[12:13], s[98:99]
    v_pk_mul_f32 v[14:15], v[14:15], s[98:99]
    v_cvt_pk_bf16_f32 v36, |v12|, |v13|
    v_cvt_pk_bf16_f32 v37, |v14|, |v15|
    v_or3_b32 v6, v6, v36, v37
    s_waitcnt lgkmcnt(8)
    v_lshl_or_b32 v103, v21, 16, v20
    v_lshl_or_b32 v105, v23, 16, v22
    s_waitcnt vmcnt(10)
    v_lshlrev_b32 v12, 16, v44
    v_and_b32 v13, 0xffff0000, v44
    v_lshlrev_b32 v14, 16, v45
    v_and_b32 v15, 0xffff0000, v45
    v_pk_mul_f32 v[12:13], v[12:13], s[98:99]
    v_pk_mul_f32 v[14:15], v[14:15], s[98:99]
    v_cvt_pk_bf16_f32 v44, |v12|, |v13|
    v_cvt_pk_bf16_f32 v45, |v14|, |v15|
    v_or3_b32 v6, v6, v44, v45
    s_waitcnt lgkmcnt(4)
    v_lshl_or_b32 v111, v25, 16, v24
    v_lshl_or_b32 v113, v27, 16, v26
    s_waitcnt vmcnt(9)
    v_lshlrev_b32 v12, 16, v52
    v_and_b32 v13, 0xffff0000, v52
    v_lshlrev_b32 v14, 16, v53
    v_and_b32 v15, 0xffff0000, v53
    v_pk_mul_f32 v[12:13], v[12:13], s[98:99]
    v_pk_mul_f32 v[14:15], v[14:15], s[98:99]
    v_cvt_pk_bf16_f32 v52, |v12|, |v13|
    v_cvt_pk_bf16_f32 v53, |v14|, |v15|
    v_or3_b32 v6, v6, v52, v53
    v_mov_b32 v15, v0
    s_lshl_b32 s69, s100, 2
    v_xor_b32 v15, s69, v15
    v_lshlrev_b32 v26, 2, v15
    v_mov_b64 v[22:23], v[16:17]
    v_mov_b64 v[24:25], v[18:19]
    v_lshrrev_b32 v2, 3, v0
    v_mul_u32_u24 v2, 192, v2
    v_bfe_u32 v7, v0, 1, 2
    v_lshl_add_u32 v2, v7, 3, v2
    v_and_b32 v7, 1, v0
    v_mul_u32_u24 v7, 96, v7
    v_add_u32 v2, v2, v7
    s_mov_b32 s65, 0x07060302
    s_mov_b32 s66, 0x05040100
    s_movk_i32 s45, 1024
    s_mul_i32 s69, s2, 32768
    s_add_u32 s8, s94, s69
    s_addc_u32 s9, s95, 0
    s_and_b32 s9, s9, 0xffff
    s_mov_b32 s10, 32768
    s_mov_b32 s11, 0x20000
    s_mul_i32 s69, s2, 6250
    v_lshlrev_b32 v7, 7, v0
    s_add_u32 s12, s96, s69
    s_addc_u32 s13, s97, 0
    s_and_b32 s13, s13, 0xffff
    s_mov_b32 s14, 6250
    s_mov_b32 s15, 0x20000
    buffer_load_ushort v29, v7, s[12:15], 0 offen
    v_and_b32 v7, 63, v0
    s_mul_i32 s69, s64, 16
    v_cmp_gt_u32 vcc, 16, v7
    v_add_u32 v7, s69, v7
    v_lshlrev_b32 v7, 7, v7
    v_cndmask_b32 v7, -1, v7, vcc
    s_waitcnt lgkmcnt(0)
    v_lshl_or_b32 v119, v9, 16, v8
    v_lshl_or_b32 v121, v11, 16, v10
    s_barrier
    s_cmp_lt_u32 s64, 15
    s_cbranch_scc1 A_noprobe1
    s_lshl_b32 s69, s64, 9
    s_add_u32 s69, s69, 638980
    s_mov_b32 s71, 0
    s_waitcnt vmcnt(10)
    s_xor_b32 s70, s69, 8192
    s_waitcnt lgkmcnt(0)
    s_mov_b64 s[4:5], 0
    s_buffer_load_dword s4, s[20:23], s69
    s_buffer_load_dword s5, s[20:23], s70
    s_add_u32 s69, s70, 128
    s_waitcnt lgkmcnt(1)
    s_sub_i32 s6, s4, s5
    s_add_i32 s71, s71, s6
    s_xor_b32 s70, s69, 8192
    s_waitcnt lgkmcnt(0)
    s_mov_b64 s[4:5], 0
    s_buffer_load_dword s5, s[20:23], s69
    s_buffer_load_dword s4, s[20:23], s70
    s_add_u32 s69, s70, 128
    s_waitcnt lgkmcnt(1)
    s_sub_i32 s6, s4, s5
    s_add_i32 s71, s71, s6
    s_xor_b32 s70, s69, 8192
    s_waitcnt lgkmcnt(0)
    s_mov_b64 s[4:5], 0
    s_buffer_load_dword s4, s[20:23], s69
    s_buffer_load_dword s5, s[20:23], s70
    s_add_u32 s69, s70, 128
    s_waitcnt lgkmcnt(1)
    s_sub_i32 s6, s4, s5
    s_add_i32 s71, s71, s6
    s_xor_b32 s70, s69, 8192
    s_waitcnt lgkmcnt(0)
    s_mov_b64 s[4:5], 0
    s_buffer_load_dword s5, s[20:23], s69
    s_buffer_load_dword s4, s[20:23], s70
    s_add_u32 s69, s70, 128
    s_waitcnt lgkmcnt(1)
    s_sub_i32 s6, s4, s5
    s_add_i32 s71, s71, s6
    v_mov_b32 v4, 0
    v_mov_b32 v5, s71
    s_mov_b64 exec, 1
    ds_add_u32 v4, v5 offset:4
    s_mov_b64 exec, -1
A_noprobe1:
    s_mov_b32 s71, 64
    s_mov_b32 s69, 0
    buffer_load_dword v0, v7, s[8:11], s69 offen
    s_waitcnt vmcnt(14)
    v_lshlrev_b32 v9, 16, v28
    v_mul_f32 v9, s98, v9
    v_cvt_pk_bf16_f32 v9, 0, |v9|
    v_or_b32 v127, v9, v127
    v_or_b32 v6, v6, v9
    v_mad_u32_u16 v4, v127, 8, s71
    ds_write_b64 v4, v[126:127]
    v_perm_b32 v8, v36, v31, s65
    v_perm_b32 v31, v36, v31, s66
    v_mov_b32 v36, v35
    v_perm_b32 v35, v37, v33, s66
    v_perm_b32 v37, v37, v33, s65
    v_mov_b32 v33, v8
    v_mad_u32_u16 v5, v31, 8, s71
    ds_write_b64 v5, v[30:31]
    v_mad_u32_u16 v4, v33, 8, s71
    ds_write_b64 v4, v[32:33]
    v_mad_u32_u16 v5, v35, 8, s71
    ds_write_b64 v5, v[34:35]
    v_mad_u32_u16 v4, v37, 8, s71
    ds_write_b64 v4, v[36:37]
    v_perm_b32 v8, v44, v39, s65
    v_perm_b32 v39, v44, v39, s66
    v_mov_b32 v44, v43
    v_perm_b32 v43, v45, v41, s66
    v_perm_b32 v45, v45, v41, s65
    v_mov_b32 v41, v8
    v_mad_u32_u16 v5, v39, 8, s71
    ds_write_b64 v5, v[38:39]
    v_mad_u32_u16 v4, v41, 8, s71
    ds_write_b64 v4, v[40:41]
    v_mad_u32_u16 v5, v43, 8, s71
    ds_write_b64 v5, v[42:43]
    v_mad_u32_u16 v4, v45, 8, s71
    ds_write_b64 v4, v[44:45]
    v_perm_b32 v8, v52, v47, s65
    v_perm_b32 v47, v52, v47, s66
    v_mov_b32 v52, v51
    v_perm_b32 v51, v53, v49, s66
    v_perm_b32 v53, v53, v49, s65
    v_mov_b32 v49, v8
    v_mad_u32_u16 v5, v47, 8, s71
    ds_write_b64 v5, v[46:47]
    v_mad_u32_u16 v4, v49, 8, s71
    ds_write_b64 v4, v[48:49]
    v_mad_u32_u16 v5, v51, 8, s71
    ds_write_b64 v5, v[50:51]
    v_mad_u32_u16 v4, v53, 8, s71
    ds_write_b64 v4, v[52:53]
    s_waitcnt vmcnt(10)
    v_lshlrev_b32 v12, 16, v60
    v_and_b32 v13, 0xffff0000, v60
    v_lshlrev_b32 v14, 16, v61
    v_and_b32 v15, 0xffff0000, v61
    v_pk_mul_f32 v[12:13], v[12:13], s[98:99]
    v_pk_mul_f32 v[14:15], v[14:15], s[98:99]
    v_cvt_pk_bf16_f32 v60, |v12|, |v13|
    v_cvt_pk_bf16_f32 v61, |v14|, |v15|
    v_or3_b32 v6, v6, v60, v61
    v_perm_b32 v8, v60, v55, s65
    v_perm_b32 v55, v60, v55, s66
    v_mov_b32 v60, v59
    v_perm_b32 v59, v61, v57, s66
    v_perm_b32 v61, v61, v57, s65
    v_mov_b32 v57, v8
    v_mad_u32_u16 v5, v55, 8, s71
    ds_write_b64 v5, v[54:55]
    v_mad_u32_u16 v4, v57, 8, s71
    ds_write_b64 v4, v[56:57]
    v_mad_u32_u16 v5, v59, 8, s71
    ds_write_b64 v5, v[58:59]
    v_mad_u32_u16 v4, v61, 8, s71
    ds_write_b64 v4, v[60:61]
    s_waitcnt vmcnt(9)
    v_lshlrev_b32 v12, 16, v68
    v_and_b32 v13, 0xffff0000, v68
    v_lshlrev_b32 v14, 16, v69
    v_and_b32 v15, 0xffff0000, v69
    v_pk_mul_f32 v[12:13], v[12:13], s[98:99]
    v_pk_mul_f32 v[14:15], v[14:15], s[98:99]
    v_cvt_pk_bf16_f32 v68, |v12|, |v13|
    v_cvt_pk_bf16_f32 v69, |v14|, |v15|
    v_or3_b32 v6, v6, v68, v69
    v_perm_b32 v8, v68, v63, s65
    v_perm_b32 v63, v68, v63, s66
    v_mov_b32 v68, v67
    v_perm_b32 v67, v69, v65, s66
    v_perm_b32 v69, v69, v65, s65
    v_mov_b32 v65, v8
    v_mad_u32_u16 v5, v63, 8, s71
    ds_write_b64 v5, v[62:63]
    v_mad_u32_u16 v4, v65, 8, s71
    ds_write_b64 v4, v[64:65]
    v_mad_u32_u16 v5, v67, 8, s71
    ds_write_b64 v5, v[66:67]
    v_mad_u32_u16 v4, v69, 8, s71
    ds_write_b64 v4, v[68:69]
    s_waitcnt vmcnt(8)
    v_lshlrev_b32 v12, 16, v76
    v_and_b32 v13, 0xffff0000, v76
    v_lshlrev_b32 v14, 16, v77
    v_and_b32 v15, 0xffff0000, v77
    v_pk_mul_f32 v[12:13], v[12:13], s[98:99]
    v_pk_mul_f32 v[14:15], v[14:15], s[98:99]
    v_cvt_pk_bf16_f32 v76, |v12|, |v13|
    v_cvt_pk_bf16_f32 v77, |v14|, |v15|
    v_or3_b32 v6, v6, v76, v77
    v_perm_b32 v8, v76, v71, s65
    v_perm_b32 v71, v76, v71, s66
    v_mov_b32 v76, v75
    v_perm_b32 v75, v77, v73, s66
    v_perm_b32 v77, v77, v73, s65
    v_mov_b32 v73, v8
    v_mad_u32_u16 v5, v71, 8, s71
    ds_write_b64 v5, v[70:71]
    v_mad_u32_u16 v4, v73, 8, s71
    ds_write_b64 v4, v[72:73]
    v_mad_u32_u16 v5, v75, 8, s71
    ds_write_b64 v5, v[74:75]
    v_mad_u32_u16 v4, v77, 8, s71
    ds_write_b64 v4, v[76:77]
    s_waitcnt vmcnt(7)
    v_lshlrev_b32 v12, 16, v84
    v_and_b32 v13, 0xffff0000, v84
    v_lshlrev_b32 v14, 16, v85
    v_and_b32 v15, 0xffff0000, v85
    v_pk_mul_f32 v[12:13], v[12:13], s[98:99]
    v_pk_mul_f32 v[14:15], v[14:15], s[98:99]
    v_cvt_pk_bf16_f32 v84, |v12|, |v13|
    v_cvt_pk_bf16_f32 v85, |v14|, |v15|
    v_or3_b32 v6, v6, v84, v85
    v_perm_b32 v8, v84, v79, s65
    v_perm_b32 v79, v84, v79, s66
    v_mov_b32 v84, v83
    v_perm_b32 v83, v85, v81, s66
    v_perm_b32 v85, v85, v81, s65
    v_mov_b32 v81, v8
    v_mad_u32_u16 v5, v79, 8, s71
    ds_write_b64 v5, v[78:79]
    v_mad_u32_u16 v4, v81, 8, s71
    ds_write_b64 v4, v[80:81]
    v_mad_u32_u16 v5, v83, 8, s71
    ds_write_b64 v5, v[82:83]
    v_mad_u32_u16 v4, v85, 8, s71
    ds_write_b64 v4, v[84:85]
    s_waitcnt vmcnt(6)
    v_lshlrev_b32 v12, 16, v92
    v_and_b32 v13, 0xffff0000, v92
    v_lshlrev_b32 v14, 16, v93
    v_and_b32 v15, 0xffff0000, v93
    v_pk_mul_f32 v[12:13], v[12:13], s[98:99]
    v_pk_mul_f32 v[14:15], v[14:15], s[98:99]
    v_cvt_pk_bf16_f32 v92, |v12|, |v13|
    v_cvt_pk_bf16_f32 v93, |v14|, |v15|
    v_or3_b32 v6, v6, v92, v93
    v_perm_b32 v8, v92, v87, s65
    v_perm_b32 v87, v92, v87, s66
    v_mov_b32 v92, v91
    v_perm_b32 v91, v93, v89, s66
    v_perm_b32 v93, v93, v89, s65
    v_mov_b32 v89, v8
    v_mad_u32_u16 v5, v87, 8, s71
    ds_write_b64 v5, v[86:87]
    v_mad_u32_u16 v4, v89, 8, s71
    ds_write_b64 v4, v[88:89]
    v_mad_u32_u16 v5, v91, 8, s71
    ds_write_b64 v5, v[90:91]
    v_mad_u32_u16 v4, v93, 8, s71
    ds_write_b64 v4, v[92:93]
    s_waitcnt vmcnt(5)
    v_lshlrev_b32 v12, 16, v100
    v_and_b32 v13, 0xffff0000, v100
    v_lshlrev_b32 v14, 16, v101
    v_and_b32 v15, 0xffff0000, v101
    v_pk_mul_f32 v[12:13], v[12:13], s[98:99]
    v_pk_mul_f32 v[14:15], v[14:15], s[98:99]
    v_cvt_pk_bf16_f32 v100, |v12|, |v13|
    v_cvt_pk_bf16_f32 v101, |v14|, |v15|
    v_or3_b32 v6, v6, v100, v101
    v_perm_b32 v8, v100, v95, s65
    v_perm_b32 v95, v100, v95, s66
    v_mov_b32 v100, v99
    v_perm_b32 v99, v101, v97, s66
    v_perm_b32 v101, v101, v97, s65
    v_mov_b32 v97, v8
    v_mad_u32_u16 v5, v95, 8, s71
    ds_write_b64 v5, v[94:95]
    v_mad_u32_u16 v4, v97, 8, s71
    ds_write_b64 v4, v[96:97]
    v_mad_u32_u16 v5, v99, 8, s71
    ds_write_b64 v5, v[98:99]
    v_mad_u32_u16 v4, v101, 8, s71
    ds_write_b64 v4, v[100:101]
    s_waitcnt vmcnt(4)
    v_lshlrev_b32 v12, 16, v108
    v_and_b32 v13, 0xffff0000, v108
    v_lshlrev_b32 v14, 16, v109
    v_and_b32 v15, 0xffff0000, v109
    v_pk_mul_f32 v[12:13], v[12:13], s[98:99]
    v_pk_mul_f32 v[14:15], v[14:15], s[98:99]
    v_cvt_pk_bf16_f32 v108, |v12|, |v13|
    v_cvt_pk_bf16_f32 v109, |v14|, |v15|
    v_or3_b32 v6, v6, v108, v109
    v_perm_b32 v8, v108, v103, s65
    v_perm_b32 v103, v108, v103, s66
    v_mov_b32 v108, v107
    v_perm_b32 v107, v109, v105, s66
    v_perm_b32 v109, v109, v105, s65
    v_mov_b32 v105, v8
    v_mad_u32_u16 v5, v103, 8, s71
    ds_write_b64 v5, v[102:103]
    v_mad_u32_u16 v4, v105, 8, s71
    ds_write_b64 v4, v[104:105]
    v_mad_u32_u16 v5, v107, 8, s71
    ds_write_b64 v5, v[106:107]
    v_mad_u32_u16 v4, v109, 8, s71
    ds_write_b64 v4, v[108:109]
    s_waitcnt vmcnt(3)
    v_lshlrev_b32 v12, 16, v116
    v_and_b32 v13, 0xffff0000, v116
    v_lshlrev_b32 v14, 16, v117
    v_and_b32 v15, 0xffff0000, v117
    v_pk_mul_f32 v[12:13], v[12:13], s[98:99]
    v_pk_mul_f32 v[14:15], v[14:15], s[98:99]
    v_cvt_pk_bf16_f32 v116, |v12|, |v13|
    v_cvt_pk_bf16_f32 v117, |v14|, |v15|
    v_or3_b32 v6, v6, v116, v117
    v_perm_b32 v8, v116, v111, s65
    v_perm_b32 v111, v116, v111, s66
    v_mov_b32 v116, v115
    v_perm_b32 v115, v117, v113, s66
    v_perm_b32 v117, v117, v113, s65
    v_mov_b32 v113, v8
    v_mad_u32_u16 v5, v111, 8, s71
    ds_write_b64 v5, v[110:111]
    v_mad_u32_u16 v4, v113, 8, s71
    ds_write_b64 v4, v[112:113]
    v_mad_u32_u16 v5, v115, 8, s71
    ds_write_b64 v5, v[114:115]
    v_mad_u32_u16 v4, v117, 8, s71
    ds_write_b64 v4, v[116:117]
    s_waitcnt vmcnt(2)
    v_lshlrev_b32 v12, 16, v124
    v_and_b32 v13, 0xffff0000, v124
    v_lshlrev_b32 v14, 16, v125
    v_and_b32 v15, 0xffff0000, v125
    v_pk_mul_f32 v[12:13], v[12:13], s[98:99]
    v_pk_mul_f32 v[14:15], v[14:15], s[98:99]
    v_cvt_pk_bf16_f32 v124, |v12|, |v13|
    v_cvt_pk_bf16_f32 v125, |v14|, |v15|
    v_or3_b32 v6, v6, v124, v125
    v_perm_b32 v8, v124, v119, s65
    v_perm_b32 v119, v124, v119, s66
    v_mov_b32 v124, v123
    v_perm_b32 v123, v125, v121, s66
    v_perm_b32 v125, v125, v121, s65
    v_mov_b32 v121, v8
    v_mad_u32_u16 v5, v119, 8, s71
    ds_write_b64 v5, v[118:119]
    v_mad_u32_u16 v4, v121, 8, s71
    ds_write_b64 v4, v[120:121]
    v_mad_u32_u16 v5, v123, 8, s71
    ds_write_b64 v5, v[122:123]
    v_mad_u32_u16 v4, v125, 8, s71
    ds_write_b64 v4, v[124:125]
    v_and_b32 v9, 0xfc00fc00, v6
    v_mov_b32 v3, 0
    v_cmp_ne_u32 vcc, 0, v9
    s_mov_b64 exec, vcc
    ds_write_b32 v3, v9
    s_mov_b64 exec, -1
    v_lshrrev_b32 v8, 7, v1
    v_and_b32 v9, 0x2000, v1
    s_lshl_b32 s69, s3, 13
    v_add3_u32 v1, v1, v9, s69
    s_waitcnt lgkmcnt(0) vmcnt(1)
    s_barrier
    ds_read_b32 v9, v3 offset:4
    ds_read_b32 v3, v3
    ds_read_b64 v[10:11], v2 offset:64
    ds_read_b64 v[4:5], v2 offset:96
    ds_read_b64 v[12:13], v2 offset:128
    ds_read_b64 v[14:15], v2 offset:12352
    ds_read_b64 v[6:7], v2 offset:12384
    ds_read_b64 v[16:17], v2 offset:12416
    s_waitcnt lgkmcnt(3)
    v_lshrrev_b32 v9, 31, v9
    v_cmp_ne_u32 vcc, 0, v3
    v_lshlrev_b32 v3, 12, v9
    v_lshlrev_b32 v9, 13, v9
    v_xor_b32 v22, v22, v3
    v_xor_b32 v1, v1, v9
    v_xor_b32 v9, 0x2000, v1
    s_lshl_b32 s69, s2, 12
    s_mov_b32 exec_lo, 0x11111111
    s_mov_b32 exec_hi, 0x11111111
    buffer_store_dwordx4 v[22:25], v26, s[24:27], s69 offen sc1
    s_mov_b64 exec, -1
    s_cbranch_vccnz A_esc0_0
A_pack0_0:
    v_lshlrev_b32_sdwa v11, 20, v11 dst_sel:DWORD dst_unused:UNUSED_PAD src0_sel:DWORD src1_sel:WORD_1
    v_mad_u32_u16 v11, v5, s45, v11 op_sel:[1,0,0,0]
    v_mad_u32_u16 v13, v13, 1, v11 op_sel:[1,0,0,0]
    v_mov_b32 v11, v4
    s_cmp_ge_u32 s64, 8
    s_cbranch_scc1 A_half0
    s_sub_i32 s69, s101, 0
    v_cmp_le_i32 s[62:63], s69, v8
    s_mov_b32 s69, 0
    s_nop 0
    v_cndmask_b32 v3, v1, v9, s[62:63]
    buffer_store_dwordx4 v[10:13], v3, s[20:23], s69 offen sc1
A_half0:
    ds_read_b64 v[18:19], v2 offset:36928
    ds_read_b64 v[4:5], v2 offset:36960
    ds_read_b64 v[20:21], v2 offset:36992
    s_waitcnt lgkmcnt(3)
    s_cbranch_vccnz A_esc0_1
A_pack0_1:
    v_lshlrev_b32_sdwa v15, 20, v15 dst_sel:DWORD dst_unused:UNUSED_PAD src0_sel:DWORD src1_sel:WORD_1
    v_mad_u32_u16 v15, v7, s45, v15 op_sel:[1,0,0,0]
    v_mad_u32_u16 v17, v17, 1, v15 op_sel:[1,0,0,0]
    v_mov_b32 v15, v6
    s_sub_i32 s69, s101, 64
    v_cmp_le_i32 s[62:63], s69, v8
    s_mov_b32 s69, 16384
    s_nop 0
    v_cndmask_b32 v3, v1, v9, s[62:63]
    buffer_store_dwordx4 v[14:17], v3, s[20:23], s69 offen sc1
    ds_read_b64 v[22:23], v2 offset:61504
    ds_read_b64 v[6:7], v2 offset:61536
    ds_read_b64 v[24:25], v2 offset:61568
    s_waitcnt lgkmcnt(3)
    s_cbranch_vccnz A_esc0_2
A_pack0_2:
    v_lshlrev_b32_sdwa v19, 20, v19 dst_sel:DWORD dst_unused:UNUSED_PAD src0_sel:DWORD src1_sel:WORD_1
    v_mad_u32_u16 v19, v5, s45, v19 op_sel:[1,0,0,0]
    v_mad_u32_u16 v21, v21, 1, v19 op_sel:[1,0,0,0]
    v_mov_b32 v19, v4
    v_add_u32 v2, 86016, v2
    ds_read_b64 v[26:27], v2 offset:64
    ds_read_b64 v[4:5], v2 offset:96
    ds_read_b64 v[28:29], v2 offset:128
    s_waitcnt lgkmcnt(3)
    s_cbranch_vccnz A_esc0_3
A_pack0_3:
    v_lshlrev_b32_sdwa v23, 20, v23 dst_sel:DWORD dst_unused:UNUSED_PAD src0_sel:DWORD src1_sel:WORD_1
    v_mad_u32_u16 v23, v7, s45, v23 op_sel:[1,0,0,0]
    v_mad_u32_u16 v25, v25, 1, v23 op_sel:[1,0,0,0]
    v_mov_b32 v23, v6
    ds_read_b64 v[10:11], v2 offset:24640
    ds_read_b64 v[6:7], v2 offset:24672
    ds_read_b64 v[12:13], v2 offset:24704
    s_waitcnt lgkmcnt(3)
    s_cbranch_vccnz A_esc0_4
A_pack0_4:
    v_lshlrev_b32_sdwa v27, 20, v27 dst_sel:DWORD dst_unused:UNUSED_PAD src0_sel:DWORD src1_sel:WORD_1
    v_mad_u32_u16 v27, v5, s45, v27 op_sel:[1,0,0,0]
    v_mad_u32_u16 v29, v29, 1, v27 op_sel:[1,0,0,0]
    v_mov_b32 v27, v4
    ds_read_b64 v[14:15], v2 offset:49216
    ds_read_b64 v[4:5], v2 offset:49248
    ds_read_b64 v[16:17], v2 offset:49280
    s_waitcnt lgkmcnt(3)
    s_cbranch_vccnz A_esc0_5
A_pack0_5:
    v_lshlrev_b32_sdwa v11, 20, v11 dst_sel:DWORD dst_unused:UNUSED_PAD src0_sel:DWORD src1_sel:WORD_1
    v_mad_u32_u16 v11, v7, s45, v11 op_sel:[1,0,0,0]
    v_mad_u32_u16 v13, v13, 1, v11 op_sel:[1,0,0,0]
    v_mov_b32 v11, v6
    s_waitcnt lgkmcnt(0)
    s_cbranch_vccnz A_esc0_6
A_pack0_6:
    v_lshlrev_b32_sdwa v15, 20, v15 dst_sel:DWORD dst_unused:UNUSED_PAD src0_sel:DWORD src1_sel:WORD_1
    v_mad_u32_u16 v15, v5, s45, v15 op_sel:[1,0,0,0]
    v_mad_u32_u16 v17, v17, 1, v15 op_sel:[1,0,0,0]
    v_mov_b32 v15, v4
    s_barrier
    s_mov_b32 s71, 4294807616
    s_sub_i32 s69, s101, 192
    v_cmp_le_i32 s[62:63], s69, v8
    s_mov_b32 s69, 49152
    s_nop 0
    v_cndmask_b32 v3, v1, v9, s[62:63]
    buffer_store_dwordx4 v[18:21], v3, s[20:23], s69 offen sc1
    v_mad_u32_u16 v4, v127, 8, s71
    ds_write_b64 v4, v[126:127]
    v_mad_u32_u16 v5, v31, 8, s71
    ds_write_b64 v5, v[30:31]
    v_mad_u32_u16 v4, v33, 8, s71
    ds_write_b64 v4, v[32:33]
    v_mad_u32_u16 v5, v35, 8, s71
    ds_write_b64 v5, v[34:35]
    v_mad_u32_u16 v4, v37, 8, s71
    ds_write_b64 v4, v[36:37]
    v_mad_u32_u16 v5, v39, 8, s71
    ds_write_b64 v5, v[38:39]
    v_mad_u32_u16 v4, v41, 8, s71
    ds_write_b64 v4, v[40:41]
    v_mad_u32_u16 v5, v43, 8, s71
    ds_write_b64 v5, v[42:43]
    v_mad_u32_u16 v4, v45, 8, s71
    ds_write_b64 v4, v[44:45]
    s_sub_i32 s69, s101, 320
    v_cmp_le_i32 s[62:63], s69, v8
    s_mov_b32 s69, 81920
    s_nop 0
    v_cndmask_b32 v3, v1, v9, s[62:63]
    buffer_store_dwordx4 v[22:25], v3, s[20:23], s69 offen sc1
    v_mad_u32_u16 v5, v47, 8, s71
    ds_write_b64 v5, v[46:47]
    v_mad_u32_u16 v4, v49, 8, s71
    ds_write_b64 v4, v[48:49]
    v_mad_u32_u16 v5, v51, 8, s71
    ds_write_b64 v5, v[50:51]
    v_mad_u32_u16 v4, v53, 8, s71
    ds_write_b64 v4, v[52:53]
    v_mad_u32_u16 v5, v55, 8, s71
    ds_write_b64 v5, v[54:55]
    v_mad_u32_u16 v4, v57, 8, s71
    ds_write_b64 v4, v[56:57]
    v_mad_u32_u16 v5, v59, 8, s71
    ds_write_b64 v5, v[58:59]
    v_mad_u32_u16 v4, v61, 8, s71
    ds_write_b64 v4, v[60:61]
    v_mad_u32_u16 v5, v63, 8, s71
    ds_write_b64 v5, v[62:63]
    s_sub_i32 s69, s101, 448
    v_cmp_le_i32 s[62:63], s69, v8
    s_mov_b32 s69, 114688
    s_nop 0
    v_cndmask_b32 v3, v1, v9, s[62:63]
    buffer_store_dwordx4 v[26:29], v3, s[20:23], s69 offen sc1
    v_mad_u32_u16 v4, v65, 8, s71
    ds_write_b64 v4, v[64:65]
    v_mad_u32_u16 v5, v67, 8, s71
    ds_write_b64 v5, v[66:67]
    v_mad_u32_u16 v4, v69, 8, s71
    ds_write_b64 v4, v[68:69]
    v_mad_u32_u16 v5, v71, 8, s71
    ds_write_b64 v5, v[70:71]
    v_mad_u32_u16 v4, v73, 8, s71
    ds_write_b64 v4, v[72:73]
    v_mad_u32_u16 v5, v75, 8, s71
    ds_write_b64 v5, v[74:75]
    v_mad_u32_u16 v4, v77, 8, s71
    ds_write_b64 v4, v[76:77]
    v_mad_u32_u16 v5, v79, 8, s71
    ds_write_b64 v5, v[78:79]
    v_mad_u32_u16 v4, v81, 8, s71
    ds_write_b64 v4, v[80:81]
    s_sub_i32 s69, s101, 576
    v_cmp_le_i32 s[62:63], s69, v8
    s_mov_b32 s69, 147456
    s_nop 0
    v_cndmask_b32 v3, v1, v9, s[62:63]
    buffer_store_dwordx4 v[10:13], v3, s[20:23], s69 offen sc1
    v_mad_u32_u16 v5, v83, 8, s71
    ds_write_b64 v5, v[82:83]
    v_mad_u32_u16 v4, v85, 8, s71
    ds_write_b64 v4, v[84:85]
    v_mad_u32_u16 v5, v87, 8, s71
    ds_write_b64 v5, v[86:87]
    v_mad_u32_u16 v4, v89, 8, s71
    ds_write_b64 v4, v[88:89]
    v_mad_u32_u16 v5, v91, 8, s71
    ds_write_b64 v5, v[90:91]
    v_mad_u32_u16 v4, v93, 8, s71
    ds_write_b64 v4, v[92:93]
    v_mad_u32_u16 v5, v95, 8, s71
    ds_write_b64 v5, v[94:95]
    v_mad_u32_u16 v4, v97, 8, s71
    ds_write_b64 v4, v[96:97]
    v_mad_u32_u16 v5, v99, 8, s71
    ds_write_b64 v5, v[98:99]
    s_sub_i32 s69, s101, 704
    v_cmp_le_i32 s[62:63], s69, v8
    s_mov_b32 s69, 180224
    s_nop 0
    v_cndmask_b32 v3, v1, v9, s[62:63]
    buffer_store_dwordx4 v[14:17], v3, s[20:23], s69 offen sc1
    v_mad_u32_u16 v4, v101, 8, s71
    ds_write_b64 v4, v[100:101]
    v_mad_u32_u16 v5, v103, 8, s71
    ds_write_b64 v5, v[102:103]
    v_mad_u32_u16 v4, v105, 8, s71
    ds_write_b64 v4, v[104:105]
    v_mad_u32_u16 v5, v107, 8, s71
    ds_write_b64 v5, v[106:107]
    v_mad_u32_u16 v4, v109, 8, s71
    ds_write_b64 v4, v[108:109]
    v_mad_u32_u16 v5, v111, 8, s71
    ds_write_b64 v5, v[110:111]
    v_mad_u32_u16 v4, v113, 8, s71
    ds_write_b64 v4, v[112:113]
    v_mad_u32_u16 v5, v115, 8, s71
    ds_write_b64 v5, v[114:115]
    v_mad_u32_u16 v4, v117, 8, s71
    ds_write_b64 v4, v[116:117]
    v_mad_u32_u16 v5, v119, 8, s71
    ds_write_b64 v5, v[118:119]
    v_mad_u32_u16 v4, v121, 8, s71
    ds_write_b64 v4, v[120:121]
    v_mad_u32_u16 v5, v123, 8, s71
    ds_write_b64 v5, v[122:123]
    v_mad_u32_u16 v4, v125, 8, s71
    ds_write_b64 v4, v[124:125]
    s_waitcnt lgkmcnt(0)
    s_barrier
    v_add_u32 v2, 4294881280, v2
    ds_read_b64 v[10:11], v2 offset:64
    ds_read_b64 v[4:5], v2 offset:96
    ds_read_b64 v[12:13], v2 offset:128
    ds_read_b64 v[14:15], v2 offset:12352
    ds_read_b64 v[6:7], v2 offset:12384
    ds_read_b64 v[16:17], v2 offset:12416
    s_waitcnt lgkmcnt(3)
    s_cbranch_vccnz A_esc1_0
A_pack1_0:
    v_lshlrev_b32_sdwa v11, 20, v11 dst_sel:DWORD dst_unused:UNUSED_PAD src0_sel:DWORD src1_sel:WORD_1
    v_mad_u32_u16 v11, v5, s45, v11 op_sel:[1,0,0,0]
    v_mad_u32_u16 v13, v13, 1, v11 op_sel:[1,0,0,0]
    v_mov_b32 v11, v4
    s_cmp_ge_u32 s64, 8
    s_cbranch_scc1 A_half1
    s_sub_i32 s69, s101, 832
    v_cmp_le_i32 s[62:63], s69, v8
    s_mov_b32 s69, 212992
    s_nop 0
    v_cndmask_b32 v3, v1, v9, s[62:63]
    buffer_store_dwordx4 v[10:13], v3, s[20:23], s69 offen sc1
A_half1:
    ds_read_b64 v[18:19], v2 offset:36928
    ds_read_b64 v[4:5], v2 offset:36960
    ds_read_b64 v[20:21], v2 offset:36992
    s_waitcnt lgkmcnt(3)
    s_cbranch_vccnz A_esc1_1
A_pack1_1:
    v_lshlrev_b32_sdwa v15, 20, v15 dst_sel:DWORD dst_unused:UNUSED_PAD src0_sel:DWORD src1_sel:WORD_1
    v_mad_u32_u16 v15, v7, s45, v15 op_sel:[1,0,0,0]
    v_mad_u32_u16 v17, v17, 1, v15 op_sel:[1,0,0,0]
    v_mov_b32 v15, v6
    s_sub_i32 s69, s101, 896
    v_cmp_le_i32 s[62:63], s69, v8
    s_mov_b32 s69, 229376
    s_nop 0
    v_cndmask_b32 v3, v1, v9, s[62:63]
    buffer_store_dwordx4 v[14:17], v3, s[20:23], s69 offen sc1
    ds_read_b64 v[22:23], v2 offset:61504
    ds_read_b64 v[6:7], v2 offset:61536
    ds_read_b64 v[24:25], v2 offset:61568
    s_waitcnt lgkmcnt(3)
    s_cbranch_vccnz A_esc1_2
A_pack1_2:
    v_lshlrev_b32_sdwa v19, 20, v19 dst_sel:DWORD dst_unused:UNUSED_PAD src0_sel:DWORD src1_sel:WORD_1
    v_mad_u32_u16 v19, v5, s45, v19 op_sel:[1,0,0,0]
    v_mad_u32_u16 v21, v21, 1, v19 op_sel:[1,0,0,0]
    v_mov_b32 v19, v4
    v_add_u32 v2, 86016, v2
    ds_read_b64 v[26:27], v2 offset:64
    ds_read_b64 v[4:5], v2 offset:96
    ds_read_b64 v[28:29], v2 offset:128
    s_waitcnt lgkmcnt(3)
    s_cbranch_vccnz A_esc1_3
A_pack1_3:
    v_lshlrev_b32_sdwa v23, 20, v23 dst_sel:DWORD dst_unused:UNUSED_PAD src0_sel:DWORD src1_sel:WORD_1
    v_mad_u32_u16 v23, v7, s45, v23 op_sel:[1,0,0,0]
    v_mad_u32_u16 v25, v25, 1, v23 op_sel:[1,0,0,0]
    v_mov_b32 v23, v6
    ds_read_b64 v[10:11], v2 offset:24640
    ds_read_b64 v[6:7], v2 offset:24672
    ds_read_b64 v[12:13], v2 offset:24704
    s_waitcnt lgkmcnt(3)
    s_cbranch_vccnz A_esc1_4
A_pack1_4:
    v_lshlrev_b32_sdwa v27, 20, v27 dst_sel:DWORD dst_unused:UNUSED_PAD src0_sel:DWORD src1_sel:WORD_1
    v_mad_u32_u16 v27, v5, s45, v27 op_sel:[1,0,0,0]
    v_mad_u32_u16 v29, v29, 1, v27 op_sel:[1,0,0,0]
    v_mov_b32 v27, v4
    ds_read_b64 v[14:15], v2 offset:49216
    ds_read_b64 v[4:5], v2 offset:49248
    ds_read_b64 v[16:17], v2 offset:49280
    s_waitcnt lgkmcnt(3)
    s_cbranch_vccnz A_esc1_5
A_pack1_5:
    v_lshlrev_b32_sdwa v11, 20, v11 dst_sel:DWORD dst_unused:UNUSED_PAD src0_sel:DWORD src1_sel:WORD_1
    v_mad_u32_u16 v11, v7, s45, v11 op_sel:[1,0,0,0]
    v_mad_u32_u16 v13, v13, 1, v11 op_sel:[1,0,0,0]
    v_mov_b32 v11, v6
    s_waitcnt lgkmcnt(0)
    s_cbranch_vccnz A_esc1_6
A_pack1_6:
    v_lshlrev_b32_sdwa v15, 20, v15 dst_sel:DWORD dst_unused:UNUSED_PAD src0_sel:DWORD src1_sel:WORD_1
    v_mad_u32_u16 v15, v5, s45, v15 op_sel:[1,0,0,0]
    v_mad_u32_u16 v17, v17, 1, v15 op_sel:[1,0,0,0]
    v_mov_b32 v15, v4
    s_barrier
    s_mov_b32 s71, 4294647872
    s_sub_i32 s69, s101, 1024
    v_cmp_le_i32 s[62:63], s69, v8
    s_mov_b32 s69, 262144
    s_nop 0
    v_cndmask_b32 v3, v1, v9, s[62:63]
    buffer_store_dwordx4 v[18:21], v3, s[20:23], s69 offen sc1
    v_mad_u32_u16 v4, v127, 8, s71
    ds_write_b64 v4, v[126:127]
    v_mad_u32_u16 v5, v31, 8, s71
    ds_write_b64 v5, v[30:31]
    v_mad_u32_u16 v4, v33, 8, s71
    ds_write_b64 v4, v[32:33]
    v_mad_u32_u16 v5, v35, 8, s71
    ds_write_b64 v5, v[34:35]
    v_mad_u32_u16 v4, v37, 8, s71
    ds_write_b64 v4, v[36:37]
    v_mad_u32_u16 v5, v39, 8, s71
    ds_write_b64 v5, v[38:39]
    v_mad_u32_u16 v4, v41, 8, s71
    ds_write_b64 v4, v[40:41]
    v_mad_u32_u16 v5, v43, 8, s71
    ds_write_b64 v5, v[42:43]
    v_mad_u32_u16 v4, v45, 8, s71
    ds_write_b64 v4, v[44:45]
    s_sub_i32 s69, s101, 1152
    v_cmp_le_i32 s[62:63], s69, v8
    s_mov_b32 s69, 294912
    s_nop 0
    v_cndmask_b32 v3, v1, v9, s[62:63]
    buffer_store_dwordx4 v[22:25], v3, s[20:23], s69 offen sc1
    v_mad_u32_u16 v5, v47, 8, s71
    ds_write_b64 v5, v[46:47]
    v_mad_u32_u16 v4, v49, 8, s71
    ds_write_b64 v4, v[48:49]
    v_mad_u32_u16 v5, v51, 8, s71
    ds_write_b64 v5, v[50:51]
    v_mad_u32_u16 v4, v53, 8, s71
    ds_write_b64 v4, v[52:53]
    v_mad_u32_u16 v5, v55, 8, s71
    ds_write_b64 v5, v[54:55]
    v_mad_u32_u16 v4, v57, 8, s71
    ds_write_b64 v4, v[56:57]
    v_mad_u32_u16 v5, v59, 8, s71
    ds_write_b64 v5, v[58:59]
    v_mad_u32_u16 v4, v61, 8, s71
    ds_write_b64 v4, v[60:61]
    v_mad_u32_u16 v5, v63, 8, s71
    ds_write_b64 v5, v[62:63]
    s_sub_i32 s69, s101, 1280
    v_cmp_le_i32 s[62:63], s69, v8
    s_mov_b32 s69, 327680
    s_nop 0
    v_cndmask_b32 v3, v1, v9, s[62:63]
    buffer_store_dwordx4 v[26:29], v3, s[20:23], s69 offen sc1
    v_mad_u32_u16 v4, v65, 8, s71
    ds_write_b64 v4, v[64:65]
    v_mad_u32_u16 v5, v67, 8, s71
    ds_write_b64 v5, v[66:67]
    v_mad_u32_u16 v4, v69, 8, s71
    ds_write_b64 v4, v[68:69]
    v_mad_u32_u16 v5, v71, 8, s71
    ds_write_b64 v5, v[70:71]
    v_mad_u32_u16 v4, v73, 8, s71
    ds_write_b64 v4, v[72:73]
    v_mad_u32_u16 v5, v75, 8, s71
    ds_write_b64 v5, v[74:75]
    v_mad_u32_u16 v4, v77, 8, s71
    ds_write_b64 v4, v[76:77]
    v_mad_u32_u16 v5, v79, 8, s71
    ds_write_b64 v5, v[78:79]
    v_mad_u32_u16 v4, v81, 8, s71
    ds_write_b64 v4, v[80:81]
    s_sub_i32 s69, s101, 1408
    v_cmp_le_i32 s[62:63], s69, v8
    s_mov_b32 s69, 360448
    s_nop 0
    v_cndmask_b32 v3, v1, v9, s[62:63]
    buffer_store_dwordx4 v[10:13], v3, s[20:23], s69 offen sc1
    v_mad_u32_u16 v5, v83, 8, s71
    ds_write_b64 v5, v[82:83]
    v_mad_u32_u16 v4, v85, 8, s71
    ds_write_b64 v4, v[84:85]
    v_mad_u32_u16 v5, v87, 8, s71
    ds_write_b64 v5, v[86:87]
    v_mad_u32_u16 v4, v89, 8, s71
    ds_write_b64 v4, v[88:89]
    v_mad_u32_u16 v5, v91, 8, s71
    ds_write_b64 v5, v[90:91]
    v_mad_u32_u16 v4, v93, 8, s71
    ds_write_b64 v4, v[92:93]
    v_mad_u32_u16 v5, v95, 8, s71
    ds_write_b64 v5, v[94:95]
    v_mad_u32_u16 v4, v97, 8, s71
    ds_write_b64 v4, v[96:97]
    v_mad_u32_u16 v5, v99, 8, s71
    ds_write_b64 v5, v[98:99]
    s_sub_i32 s69, s101, 1536
    v_cmp_le_i32 s[62:63], s69, v8
    s_mov_b32 s69, 393216
    s_nop 0
    v_cndmask_b32 v3, v1, v9, s[62:63]
    buffer_store_dwordx4 v[14:17], v3, s[20:23], s69 offen sc1
    v_mad_u32_u16 v4, v101, 8, s71
    ds_write_b64 v4, v[100:101]
    v_mad_u32_u16 v5, v103, 8, s71
    ds_write_b64 v5, v[102:103]
    v_mad_u32_u16 v4, v105, 8, s71
    ds_write_b64 v4, v[104:105]
    v_mad_u32_u16 v5, v107, 8, s71
    ds_write_b64 v5, v[106:107]
    v_mad_u32_u16 v4, v109, 8, s71
    ds_write_b64 v4, v[108:109]
    v_mad_u32_u16 v5, v111, 8, s71
    ds_write_b64 v5, v[110:111]
    v_mad_u32_u16 v4, v113, 8, s71
    ds_write_b64 v4, v[112:113]
    v_mad_u32_u16 v5, v115, 8, s71
    ds_write_b64 v5, v[114:115]
    v_mad_u32_u16 v4, v117, 8, s71
    ds_write_b64 v4, v[116:117]
    v_mad_u32_u16 v5, v119, 8, s71
    ds_write_b64 v5, v[118:119]
    v_mad_u32_u16 v4, v121, 8, s71
    ds_write_b64 v4, v[120:121]
    v_mad_u32_u16 v5, v123, 8, s71
    ds_write_b64 v5, v[122:123]
    v_mad_u32_u16 v4, v125, 8, s71
    ds_write_b64 v4, v[124:125]
    s_waitcnt lgkmcnt(0)
    s_barrier
    v_add_u32 v2, 4294881280, v2
    ds_read_b64 v[10:11], v2 offset:64
    ds_read_b64 v[4:5], v2 offset:96
    ds_read_b64 v[12:13], v2 offset:128
    ds_read_b64 v[14:15], v2 offset:24640
    ds_read_b64 v[6:7], v2 offset:24672
    ds_read_b64 v[16:17], v2 offset:24704
    s_waitcnt lgkmcnt(3)
    s_cbranch_vccnz A_esc2_0
A_pack2_0:
    v_lshlrev_b32_sdwa v11, 20, v11 dst_sel:DWORD dst_unused:UNUSED_PAD src0_sel:DWORD src1_sel:WORD_1
    v_mad_u32_u16 v11, v5, s45, v11 op_sel:[1,0,0,0]
    v_mad_u32_u16 v13, v13, 1, v11 op_sel:[1,0,0,0]
    v_mov_b32 v11, v4
    s_sub_i32 s69, s101, 1664
    v_cmp_le_i32 s[62:63], s69, v8
    s_sub_i32 s69, s46, 1664
    v_cmp_gt_i32 s[4:5], s69, v8
    s_mov_b32 s69, 425984
    v_cndmask_b32 v3, v1, v9, s[62:63]
    v_cndmask_b32 v3, 2.0, v3, s[4:5]
    buffer_store_dwordx4 v[10:13], v3, s[20:23], s69 offen sc1
    ds_read_b64 v[18:19], v2 offset:49216
    ds_read_b64 v[4:5], v2 offset:49248
    ds_read_b64 v[20:21], v2 offset:49280
    s_waitcnt lgkmcnt(3)
    s_cbranch_vccnz A_esc2_1
A_pack2_1:
    v_lshlrev_b32_sdwa v15, 20, v15 dst_sel:DWORD dst_unused:UNUSED_PAD src0_sel:DWORD src1_sel:WORD_1
    v_mad_u32_u16 v15, v7, s45, v15 op_sel:[1,0,0,0]
    v_mad_u32_u16 v17, v17, 1, v15 op_sel:[1,0,0,0]
    v_mov_b32 v15, v6
    s_sub_i32 s69, s101, 1792
    v_cmp_le_i32 s[62:63], s69, v8
    s_sub_i32 s69, s46, 1792
    v_cmp_gt_i32 s[4:5], s69, v8
    s_mov_b32 s69, 458752
    v_cndmask_b32 v3, v1, v9, s[62:63]
    v_cndmask_b32 v3, 2.0, v3, s[4:5]
    buffer_store_dwordx4 v[14:17], v3, s[20:23], s69 offen sc1
    v_add_u32 v2, 73728, v2
    ds_read_b64 v[22:23], v2 offset:64
    ds_read_b64 v[6:7], v2 offset:96
    ds_read_b64 v[24:25], v2 offset:128
    s_waitcnt lgkmcnt(3)
    s_cbranch_vccnz A_esc2_2
A_pack2_2:
    v_lshlrev_b32_sdwa v19, 20, v19 dst_sel:DWORD dst_unused:UNUSED_PAD src0_sel:DWORD src1_sel:WORD_1
    v_mad_u32_u16 v19, v5, s45, v19 op_sel:[1,0,0,0]
    v_mad_u32_u16 v21, v21, 1, v19 op_sel:[1,0,0,0]
    v_mov_b32 v19, v4
    s_sub_i32 s69, s101, 1920
    v_cmp_le_i32 s[62:63], s69, v8
    s_sub_i32 s69, s46, 1920
    v_cmp_gt_i32 s[4:5], s69, v8
    s_mov_b32 s69, 491520
    v_cndmask_b32 v3, v1, v9, s[62:63]
    v_cndmask_b32 v3, 2.0, v3, s[4:5]
    buffer_store_dwordx4 v[18:21], v3, s[20:23], s69 offen sc1
    ds_read_b64 v[26:27], v2 offset:24640
    ds_read_b64 v[4:5], v2 offset:24672
    ds_read_b64 v[28:29], v2 offset:24704
    s_waitcnt lgkmcnt(3)
    s_cbranch_vccnz A_esc2_3
A_pack2_3:
    v_lshlrev_b32_sdwa v23, 20, v23 dst_sel:DWORD dst_unused:UNUSED_PAD src0_sel:DWORD src1_sel:WORD_1
    v_mad_u32_u16 v23, v7, s45, v23 op_sel:[1,0,0,0]
    v_mad_u32_u16 v25, v25, 1, v23 op_sel:[1,0,0,0]
    v_mov_b32 v23, v6
    s_sub_i32 s69, s101, 2048
    v_cmp_le_i32 s[62:63], s69, v8
    s_sub_i32 s69, s46, 2048
    v_cmp_gt_i32 s[4:5], s69, v8
    s_mov_b32 s69, 524288
    v_cndmask_b32 v3, v1, v9, s[62:63]
    v_cndmask_b32 v3, 2.0, v3, s[4:5]
    buffer_store_dwordx4 v[22:25], v3, s[20:23], s69 offen sc1
    s_waitcnt lgkmcnt(0)
    s_cbranch_vccnz A_esc2_4
A_pack2_4:
    v_lshlrev_b32_sdwa v27, 20, v27 dst_sel:DWORD dst_unused:UNUSED_PAD src0_sel:DWORD src1_sel:WORD_1
    v_mad_u32_u16 v27, v5, s45, v27 op_sel:[1,0,0,0]
    v_mad_u32_u16 v29, v29, 1, v27 op_sel:[1,0,0,0]
    v_mov_b32 v27, v4
    s_sub_i32 s69, s101, 2176
    v_cmp_le_i32 s[62:63], s69, v8
    s_sub_i32 s69, s46, 2176
    v_cmp_gt_i32 s[4:5], s69, v8
    s_mov_b32 s69, 557056
    v_cndmask_b32 v3, v1, v9, s[62:63]
    v_cndmask_b32 v3, 2.0, v3, s[4:5]
    buffer_store_dwordx4 v[26:29], v3, s[20:23], s69 offen sc1
    s_cmp_le_u32 s46, 2304
    s_cbranch_scc1 A_last
    ds_read_b64 v[10:11], v2 offset:49216
    ds_read_b64 v[6:7], v2 offset:49248
    ds_read_b64 v[12:13], v2 offset:49280
    s_waitcnt lgkmcnt(0)
    s_cbranch_vccnz A_esc2_5
A_pack2_5:
    v_lshlrev_b32_sdwa v11, 20, v11 dst_sel:DWORD dst_unused:UNUSED_PAD src0_sel:DWORD src1_sel:WORD_1
    v_mad_u32_u16 v11, v7, s45, v11 op_sel:[1,0,0,0]
    v_mad_u32_u16 v13, v13, 1, v11 op_sel:[1,0,0,0]
    v_mov_b32 v11, v6
    s_sub_i32 s69, s101, 2304
    v_cmp_le_i32 s[62:63], s69, v8
    s_sub_i32 s69, s46, 2304
    v_cmp_gt_i32 s[4:5], s69, v8
    s_mov_b32 s69, 589824
    v_cndmask_b32 v3, v1, v9, s[62:63]
    v_cndmask_b32 v3, 2.0, v3, s[4:5]
    buffer_store_dwordx4 v[10:13], v3, s[20:23], s69 offen sc1
A_last:
A_end:
    s_endpgm
A_esc0_0:
    v_or3_b32 v3, v11, v5, v13
    v_lshrrev_b32 v3, 26, v3
    v_cmp_ne_u32 s[6:7], 0, v3
    s_sub_i32 s69, s101, 0
    v_cmp_le_i32 s[62:63], s69, v8
    s_mov_b32 s69, 0
    s_nop 0
    v_cndmask_b32 v3, v1, v9, s[62:63]
    v_xor_b32 v3, 0x2000, v3
    s_mov_b64 exec, s[6:7]
    s_cbranch_execz A_escd0_0
    buffer_store_short_d16_hi v11, v3, s[20:23], s69 offen
    buffer_store_short_d16_hi v5, v3, s[20:23], s69 offen offset:2
    buffer_store_short_d16_hi v13, v3, s[20:23], s69 offen offset:4
    s_nop 1
    v_bfrev_b32 v11, 16
    v_mov_b32 v5, 0
    v_mov_b32 v13, 0
A_escd0_0:
    s_mov_b64 exec, -1
    s_branch A_pack0_0
A_esc0_1:
    v_or3_b32 v3, v15, v7, v17
    v_lshrrev_b32 v3, 26, v3
    v_cmp_ne_u32 s[6:7], 0, v3
    s_sub_i32 s69, s101, 64
    v_cmp_le_i32 s[62:63], s69, v8
    s_mov_b32 s69, 16384
    s_nop 0
    v_cndmask_b32 v3, v1, v9, s[62:63]
    v_xor_b32 v3, 0x2000, v3
    s_mov_b64 exec, s[6:7]
    s_cbranch_execz A_escd0_1
    buffer_store_short_d16_hi v15, v3, s[20:23], s69 offen
    buffer_store_short_d16_hi v7, v3, s[20:23], s69 offen offset:2
    buffer_store_short_d16_hi v17, v3, s[20:23], s69 offen offset:4
    s_nop 1
    v_bfrev_b32 v15, 16
    v_mov_b32 v7, 0
    v_mov_b32 v17, 0
A_escd0_1:
    s_mov_b64 exec, -1
    s_branch A_pack0_1
A_esc0_2:
    v_or3_b32 v3, v19, v5, v21
    v_lshrrev_b32 v3, 26, v3
    v_cmp_ne_u32 s[6:7], 0, v3
    s_sub_i32 s69, s101, 192
    v_cmp_le_i32 s[62:63], s69, v8
    s_mov_b32 s69, 49152
    s_nop 0
    v_cndmask_b32 v3, v1, v9, s[62:63]
    v_xor_b32 v3, 0x2000, v3
    s_mov_b64 exec, s[6:7]
    s_cbranch_execz A_escd0_2
    buffer_store_short_d16_hi v19, v3, s[20:23], s69 offen
    buffer_store_short_d16_hi v5, v3, s[20:23], s69 offen offset:2
    buffer_store_short_d16_hi v21, v3, s[20:23], s69 offen offset:4
    s_nop 1
    v_bfrev_b32 v19, 16
    v_mov_b32 v5, 0
    v_mov_b32 v21, 0
A_escd0_2:
    s_mov_b64 exec, -1
    s_branch A_pack0_2
A_esc0_3:
    v_or3_b32 v3, v23, v7, v25
    v_lshrrev_b32 v3, 26, v3
    v_cmp_ne_u32 s[6:7], 0, v3
    s_sub_i32 s69, s101, 320
    v_cmp_le_i32 s[62:63], s69, v8
    s_mov_b32 s69, 81920
    s_nop 0
    v_cndmask_b32 v3, v1, v9, s[62:63]
    v_xor_b32 v3, 0x2000, v3
    s_mov_b64 exec, s[6:7]
    s_cbranch_execz A_escd0_3
    buffer_store_short_d16_hi v23, v3, s[20:23], s69 offen
    buffer_store_short_d16_hi v7, v3, s[20:23], s69 offen offset:2
    buffer_store_short_d16_hi v25, v3, s[20:23], s69 offen offset:4
    s_nop 1
    v_bfrev_b32 v23, 16
    v_mov_b32 v7, 0
    v_mov_b32 v25, 0
A_escd0_3:
    s_mov_b64 exec, -1
    s_branch A_pack0_3
A_esc0_4:
    v_or3_b32 v3, v27, v5, v29
    v_lshrrev_b32 v3, 26, v3
    v_cmp_ne_u32 s[6:7], 0, v3
    s_sub_i32 s69, s101, 448
    v_cmp_le_i32 s[62:63], s69, v8
    s_mov_b32 s69, 114688
    s_nop 0
    v_cndmask_b32 v3, v1, v9, s[62:63]
    v_xor_b32 v3, 0x2000, v3
    s_mov_b64 exec, s[6:7]
    s_cbranch_execz A_escd0_4
    buffer_store_short_d16_hi v27, v3, s[20:23], s69 offen
    buffer_store_short_d16_hi v5, v3, s[20:23], s69 offen offset:2
    buffer_store_short_d16_hi v29, v3, s[20:23], s69 offen offset:4
    s_nop 1
    v_bfrev_b32 v27, 16
    v_mov_b32 v5, 0
    v_mov_b32 v29, 0
A_escd0_4:
    s_mov_b64 exec, -1
    s_branch A_pack0_4
A_esc0_5:
    v_or3_b32 v3, v11, v7, v13
    v_lshrrev_b32 v3, 26, v3
    v_cmp_ne_u32 s[6:7], 0, v3
    s_sub_i32 s69, s101, 576
    v_cmp_le_i32 s[62:63], s69, v8
    s_mov_b32 s69, 147456
    s_nop 0
    v_cndmask_b32 v3, v1, v9, s[62:63]
    v_xor_b32 v3, 0x2000, v3
    s_mov_b64 exec, s[6:7]
    s_cbranch_execz A_escd0_5
    buffer_store_short_d16_hi v11, v3, s[20:23], s69 offen
    buffer_store_short_d16_hi v7, v3, s[20:23], s69 offen offset:2
    buffer_store_short_d16_hi v13, v3, s[20:23], s69 offen offset:4
    s_nop 1
    v_bfrev_b32 v11, 16
    v_mov_b32 v7, 0
    v_mov_b32 v13, 0
A_escd0_5:
    s_mov_b64 exec, -1
    s_branch A_pack0_5
A_esc0_6:
    v_or3_b32 v3, v15, v5, v17
    v_lshrrev_b32 v3, 26, v3
    v_cmp_ne_u32 s[6:7], 0, v3
    s_sub_i32 s69, s101, 704
    v_cmp_le_i32 s[62:63], s69, v8
    s_mov_b32 s69, 180224
    s_nop 0
    v_cndmask_b32 v3, v1, v9, s[62:63]
    v_xor_b32 v3, 0x2000, v3
    s_mov_b64 exec, s[6:7]
    s_cbranch_execz A_escd0_6
    buffer_store_short_d16_hi v15, v3, s[20:23], s69 offen
    buffer_store_short_d16_hi v5, v3, s[20:23], s69 offen offset:2
    buffer_store_short_d16_hi v17, v3, s[20:23], s69 offen offset:4
    s_nop 1
    v_bfrev_b32 v15, 16
    v_mov_b32 v5, 0
    v_mov_b32 v17, 0
A_escd0_6:
    s_mov_b64 exec, -1
    s_branch A_pack0_6
A_esc1_0:
    v_or3_b32 v3, v11, v5, v13
    v_lshrrev_b32 v3, 26, v3
    v_cmp_ne_u32 s[6:7], 0, v3
    s_sub_i32 s69, s101, 832
    v_cmp_le_i32 s[62:63], s69, v8
    s_mov_b32 s69, 212992
    s_nop 0
    v_cndmask_b32 v3, v1, v9, s[62:63]
    v_xor_b32 v3, 0x2000, v3
    s_mov_b64 exec, s[6:7]
    s_cbranch_execz A_escd1_0
    buffer_store_short_d16_hi v11, v3, s[20:23], s69 offen
    buffer_store_short_d16_hi v5, v3, s[20:23], s69 offen offset:2
    buffer_store_short_d16_hi v13, v3, s[20:23], s69 offen offset:4
    s_nop 1
    v_bfrev_b32 v11, 16
    v_mov_b32 v5, 0
    v_mov_b32 v13, 0
A_escd1_0:
    s_mov_b64 exec, -1
    s_branch A_pack1_0
A_esc1_1:
    v_or3_b32 v3, v15, v7, v17
    v_lshrrev_b32 v3, 26, v3
    v_cmp_ne_u32 s[6:7], 0, v3
    s_sub_i32 s69, s101, 896
    v_cmp_le_i32 s[62:63], s69, v8
    s_mov_b32 s69, 229376
    s_nop 0
    v_cndmask_b32 v3, v1, v9, s[62:63]
    v_xor_b32 v3, 0x2000, v3
    s_mov_b64 exec, s[6:7]
    s_cbranch_execz A_escd1_1
    buffer_store_short_d16_hi v15, v3, s[20:23], s69 offen
    buffer_store_short_d16_hi v7, v3, s[20:23], s69 offen offset:2
    buffer_store_short_d16_hi v17, v3, s[20:23], s69 offen offset:4
    s_nop 1
    v_bfrev_b32 v15, 16
    v_mov_b32 v7, 0
    v_mov_b32 v17, 0
A_escd1_1:
    s_mov_b64 exec, -1
    s_branch A_pack1_1
A_esc1_2:
    v_or3_b32 v3, v19, v5, v21
    v_lshrrev_b32 v3, 26, v3
    v_cmp_ne_u32 s[6:7], 0, v3
    s_sub_i32 s69, s101, 1024
    v_cmp_le_i32 s[62:63], s69, v8
    s_mov_b32 s69, 262144
    s_nop 0
    v_cndmask_b32 v3, v1, v9, s[62:63]
    v_xor_b32 v3, 0x2000, v3
    s_mov_b64 exec, s[6:7]
    s_cbranch_execz A_escd1_2
    buffer_store_short_d16_hi v19, v3, s[20:23], s69 offen
    buffer_store_short_d16_hi v5, v3, s[20:23], s69 offen offset:2
    buffer_store_short_d16_hi v21, v3, s[20:23], s69 offen offset:4
    s_nop 1
    v_bfrev_b32 v19, 16
    v_mov_b32 v5, 0
    v_mov_b32 v21, 0
A_escd1_2:
    s_mov_b64 exec, -1
    s_branch A_pack1_2
A_esc1_3:
    v_or3_b32 v3, v23, v7, v25
    v_lshrrev_b32 v3, 26, v3
    v_cmp_ne_u32 s[6:7], 0, v3
    s_sub_i32 s69, s101, 1152
    v_cmp_le_i32 s[62:63], s69, v8
    s_mov_b32 s69, 294912
    s_nop 0
    v_cndmask_b32 v3, v1, v9, s[62:63]
    v_xor_b32 v3, 0x2000, v3
    s_mov_b64 exec, s[6:7]
    s_cbranch_execz A_escd1_3
    buffer_store_short_d16_hi v23, v3, s[20:23], s69 offen
    buffer_store_short_d16_hi v7, v3, s[20:23], s69 offen offset:2
    buffer_store_short_d16_hi v25, v3, s[20:23], s69 offen offset:4
    s_nop 1
    v_bfrev_b32 v23, 16
    v_mov_b32 v7, 0
    v_mov_b32 v25, 0
A_escd1_3:
    s_mov_b64 exec, -1
    s_branch A_pack1_3
A_esc1_4:
    v_or3_b32 v3, v27, v5, v29
    v_lshrrev_b32 v3, 26, v3
    v_cmp_ne_u32 s[6:7], 0, v3
    s_sub_i32 s69, s101, 1280
    v_cmp_le_i32 s[62:63], s69, v8
    s_mov_b32 s69, 327680
    s_nop 0
    v_cndmask_b32 v3, v1, v9, s[62:63]
    v_xor_b32 v3, 0x2000, v3
    s_mov_b64 exec, s[6:7]
    s_cbranch_execz A_escd1_4
    buffer_store_short_d16_hi v27, v3, s[20:23], s69 offen
    buffer_store_short_d16_hi v5, v3, s[20:23], s69 offen offset:2
    buffer_store_short_d16_hi v29, v3, s[20:23], s69 offen offset:4
    s_nop 1
    v_bfrev_b32 v27, 16
    v_mov_b32 v5, 0
    v_mov_b32 v29, 0
A_escd1_4:
    s_mov_b64 exec, -1
    s_branch A_pack1_4
A_esc1_5:
    v_or3_b32 v3, v11, v7, v13
    v_lshrrev_b32 v3, 26, v3
    v_cmp_ne_u32 s[6:7], 0, v3
    s_sub_i32 s69, s101, 1408
    v_cmp_le_i32 s[62:63], s69, v8
    s_mov_b32 s69, 360448
    s_nop 0
    v_cndmask_b32 v3, v1, v9, s[62:63]
    v_xor_b32 v3, 0x2000, v3
    s_mov_b64 exec, s[6:7]
    s_cbranch_execz A_escd1_5
    buffer_store_short_d16_hi v11, v3, s[20:23], s69 offen
    buffer_store_short_d16_hi v7, v3, s[20:23], s69 offen offset:2
    buffer_store_short_d16_hi v13, v3, s[20:23], s69 offen offset:4
    s_nop 1
    v_bfrev_b32 v11, 16
    v_mov_b32 v7, 0
    v_mov_b32 v13, 0
A_escd1_5:
    s_mov_b64 exec, -1
    s_branch A_pack1_5
A_esc1_6:
    v_or3_b32 v3, v15, v5, v17
    v_lshrrev_b32 v3, 26, v3
    v_cmp_ne_u32 s[6:7], 0, v3
    s_sub_i32 s69, s101, 1536
    v_cmp_le_i32 s[62:63], s69, v8
    s_mov_b32 s69, 393216
    s_nop 0
    v_cndmask_b32 v3, v1, v9, s[62:63]
    v_xor_b32 v3, 0x2000, v3
    s_mov_b64 exec, s[6:7]
    s_cbranch_execz A_escd1_6
    buffer_store_short_d16_hi v15, v3, s[20:23], s69 offen
    buffer_store_short_d16_hi v5, v3, s[20:23], s69 offen offset:2
    buffer_store_short_d16_hi v17, v3, s[20:23], s69 offen offset:4
    s_nop 1
    v_bfrev_b32 v15, 16
    v_mov_b32 v5, 0
    v_mov_b32 v17, 0
A_escd1_6:
    s_mov_b64 exec, -1
    s_branch A_pack1_6
A_esc2_0:
    v_or3_b32 v3, v11, v5, v13
    v_lshrrev_b32 v3, 26, v3
    v_cmp_ne_u32 s[6:7], 0, v3
    s_sub_i32 s69, s101, 1664
    v_cmp_le_i32 s[62:63], s69, v8
    s_sub_i32 s69, s46, 1664
    v_cmp_gt_i32 s[4:5], s69, v8
    s_mov_b32 s69, 425984
    v_cndmask_b32 v3, v1, v9, s[62:63]
    v_cndmask_b32 v3, 2.0, v3, s[4:5]
    v_xor_b32 v3, 0x2000, v3
    s_mov_b64 exec, s[6:7]
    s_cbranch_execz A_escd2_0
    buffer_store_short_d16_hi v11, v3, s[20:23], s69 offen
    buffer_store_short_d16_hi v5, v3, s[20:23], s69 offen offset:2
    buffer_store_short_d16_hi v13, v3, s[20:23], s69 offen offset:4
    s_nop 1
    v_bfrev_b32 v11, 16
    v_mov_b32 v5, 0
    v_mov_b32 v13, 0
A_escd2_0:
    s_mov_b64 exec, -1
    s_branch A_pack2_0
A_esc2_1:
    v_or3_b32 v3, v15, v7, v17
    v_lshrrev_b32 v3, 26, v3
    v_cmp_ne_u32 s[6:7], 0, v3
    s_sub_i32 s69, s101, 1792
    v_cmp_le_i32 s[62:63], s69, v8
    s_sub_i32 s69, s46, 1792
    v_cmp_gt_i32 s[4:5], s69, v8
    s_mov_b32 s69, 458752
    v_cndmask_b32 v3, v1, v9, s[62:63]
    v_cndmask_b32 v3, 2.0, v3, s[4:5]
    v_xor_b32 v3, 0x2000, v3
    s_mov_b64 exec, s[6:7]
    s_cbranch_execz A_escd2_1
    buffer_store_short_d16_hi v15, v3, s[20:23], s69 offen
    buffer_store_short_d16_hi v7, v3, s[20:23], s69 offen offset:2
    buffer_store_short_d16_hi v17, v3, s[20:23], s69 offen offset:4
    s_nop 1
    v_bfrev_b32 v15, 16
    v_mov_b32 v7, 0
    v_mov_b32 v17, 0
A_escd2_1:
    s_mov_b64 exec, -1
    s_branch A_pack2_1
A_esc2_2:
    v_or3_b32 v3, v19, v5, v21
    v_lshrrev_b32 v3, 26, v3
    v_cmp_ne_u32 s[6:7], 0, v3
    s_sub_i32 s69, s101, 1920
    v_cmp_le_i32 s[62:63], s69, v8
    s_sub_i32 s69, s46, 1920
    v_cmp_gt_i32 s[4:5], s69, v8
    s_mov_b32 s69, 491520
    v_cndmask_b32 v3, v1, v9, s[62:63]
    v_cndmask_b32 v3, 2.0, v3, s[4:5]
    v_xor_b32 v3, 0x2000, v3
    s_mov_b64 exec, s[6:7]
    s_cbranch_execz A_escd2_2
    buffer_store_short_d16_hi v19, v3, s[20:23], s69 offen
    buffer_store_short_d16_hi v5, v3, s[20:23], s69 offen offset:2
    buffer_store_short_d16_hi v21, v3, s[20:23], s69 offen offset:4
    s_nop 1
    v_bfrev_b32 v19, 16
    v_mov_b32 v5, 0
    v_mov_b32 v21, 0
A_escd2_2:
    s_mov_b64 exec, -1
    s_branch A_pack2_2
A_esc2_3:
    v_or3_b32 v3, v23, v7, v25
    v_lshrrev_b32 v3, 26, v3
    v_cmp_ne_u32 s[6:7], 0, v3
    s_sub_i32 s69, s101, 2048
    v_cmp_le_i32 s[62:63], s69, v8
    s_sub_i32 s69, s46, 2048
    v_cmp_gt_i32 s[4:5], s69, v8
    s_mov_b32 s69, 524288
    v_cndmask_b32 v3, v1, v9, s[62:63]
    v_cndmask_b32 v3, 2.0, v3, s[4:5]
    v_xor_b32 v3, 0x2000, v3
    s_mov_b64 exec, s[6:7]
    s_cbranch_execz A_escd2_3
    buffer_store_short_d16_hi v23, v3, s[20:23], s69 offen
    buffer_store_short_d16_hi v7, v3, s[20:23], s69 offen offset:2
    buffer_store_short_d16_hi v25, v3, s[20:23], s69 offen offset:4
    s_nop 1
    v_bfrev_b32 v23, 16
    v_mov_b32 v7, 0
    v_mov_b32 v25, 0
A_escd2_3:
    s_mov_b64 exec, -1
    s_branch A_pack2_3
A_esc2_4:
    v_or3_b32 v3, v27, v5, v29
    v_lshrrev_b32 v3, 26, v3
    v_cmp_ne_u32 s[6:7], 0, v3
    s_sub_i32 s69, s101, 2176
    v_cmp_le_i32 s[62:63], s69, v8
    s_sub_i32 s69, s46, 2176
    v_cmp_gt_i32 s[4:5], s69, v8
    s_mov_b32 s69, 557056
    v_cndmask_b32 v3, v1, v9, s[62:63]
    v_cndmask_b32 v3, 2.0, v3, s[4:5]
    v_xor_b32 v3, 0x2000, v3
    s_mov_b64 exec, s[6:7]
    s_cbranch_execz A_escd2_4
    buffer_store_short_d16_hi v27, v3, s[20:23], s69 offen
    buffer_store_short_d16_hi v5, v3, s[20:23], s69 offen offset:2
    buffer_store_short_d16_hi v29, v3, s[20:23], s69 offen offset:4
    s_nop 1
    v_bfrev_b32 v27, 16
    v_mov_b32 v5, 0
    v_mov_b32 v29, 0
A_escd2_4:
    s_mov_b64 exec, -1
    s_branch A_pack2_4
A_esc2_5:
    v_or3_b32 v3, v11, v7, v13
    v_lshrrev_b32 v3, 26, v3
    v_cmp_ne_u32 s[6:7], 0, v3
    s_sub_i32 s69, s101, 2304
    v_cmp_le_i32 s[62:63], s69, v8
    s_sub_i32 s69, s46, 2304
    v_cmp_gt_i32 s[4:5], s69, v8
    s_mov_b32 s69, 589824
    v_cndmask_b32 v3, v1, v9, s[62:63]
    v_cndmask_b32 v3, 2.0, v3, s[4:5]
    v_xor_b32 v3, 0x2000, v3
    s_mov_b64 exec, s[6:7]
    s_cbranch_execz A_escd2_5
    buffer_store_short_d16_hi v11, v3, s[20:23], s69 offen
    buffer_store_short_d16_hi v7, v3, s[20:23], s69 offen offset:2
    buffer_store_short_d16_hi v13, v3, s[20:23], s69 offen offset:4
    s_nop 1
    v_bfrev_b32 v11, 16
    v_mov_b32 v7, 0
    v_mov_b32 v13, 0
A_escd2_5:
    s_mov_b64 exec, -1
    s_branch A_pack2_5
.text
.globl accum_kernel
.p2align 8
.type accum_kernel,@function
accum_kernel:
    s_cmp_ge_u32 s2, 256
    s_cbranch_scc1 B_end
    s_load_dwordx2 s[64:65], s[0:1], 104
    s_load_dwordx2 s[56:57], s[0:1], 0
    s_load_dwordx2 s[58:59], s[0:1], 24
    s_load_dwordx2 s[60:61], s[0:1], 40
    s_load_dwordx2 s[62:63], s[0:1], 88
    s_mov_b32 s3, s2
    s_lshr_b32 s4, s3, 3
    s_and_b32 s2, s3, 7
    s_lshl_b32 s2, s2, 5
    s_or_b32 s2, s2, s4
    s_lshr_b32 s4, s2, 1
    s_mul_i32 s4, s4, 6250
    s_movk_i32 s5, 3180
    s_bitcmp1_b32 s2, 0
    s_cselect_b32 s39, 0, s5
    s_cselect_b32 s5, s5, 3070
    s_add_u32 s4, s4, s39
    s_mov_b32 s67, 0
B_restart:
    v_lshrrev_b32 v126, 6, v0
    v_bfe_u32 v56, v0, 1, 2
    v_and_or_b32 v56, v0, -8, v56
    v_and_b32 v40, 1, v0
    v_lshl_or_b32 v40, v40, 2, v56
    v_lshrrev_b32 v56, 2, v40
    v_readfirstlane_b32 s32, v126
    v_lshlrev_b32 v127, 12, v56
    v_and_b32 v125, 63, v0
    s_lshl_b32 s39, s2, 4
    s_lshl_b32 s40, s4, 1
    s_lshl_b32 s41, s5, 1
    s_mov_b32 m0, 0
    s_mov_b32 s6, -24
    s_mov_b32 s7, 0xffff0000
    s_movk_i32 s44, 0x60
    v_and_b32 v126, 1, v0
    v_lshlrev_b32 v23, 4, v126
    v_mov_b32 v1, 0xfffff
    v_and_b32 v126, 7, v0
    v_lshlrev_b32 v25, 4, v126
    v_mov_b32 v122, 2080472065
    v_mov_b32 v45, 0
    v_lshlrev_b32 v80, 4, v0
    s_mov_b32 s33, 1048576
    v_cmp_gt_u32 vcc, 2064, v80
    s_mov_b64 s[46:47], 0
    s_mov_b32 s36, 0
    s_mov_b32 s100, 0x55555555
    s_mov_b32 s101, 0x55555555
    s_mov_b32 s35, 0
    s_waitcnt lgkmcnt(0)
    s_add_u32 s64, s64, 0x1fffff
    s_addc_u32 s65, s65, 0
    s_and_b32 s64, s64, 0xffe00000
    s_add_u32 s16, s64, 180355072
    s_addc_u32 s17, s65, 0
    s_and_b32 s17, s17, 0xffff
    s_mov_b32 s18, 1050640
    s_mov_b32 s19, 0x20000
    s_cmp_ge_u32 s32, 3
    s_cbranch_scc1 B_noops
    buffer_load_dwordx4 v[76:79], v80, s[16:19], s33 offen
B_noops:
    buffer_load_dwordx3 v[46:48], v127, s[16:19], s39 offen
    s_load_dwordx4 s[68:71], s[60:61], 0
    v_lshlrev_b32 v126, 3, v56
    v_lshlrev_b32 v127, 2, v56
    s_mov_b32 s12, s64
    s_and_b32 s13, s65, 0xffff
    s_or_b32 s13, s13, 8388608
    s_mov_b32 s14, 1409024
    s_mov_b32 s15, 0x20000
    s_mov_b32 s8, s56
    s_and_b32 s9, s57, 0xffff
    s_or_b32 s9, s9, 2097152
    s_mov_b32 s10, 800000
    s_mov_b32 s11, 0x20000
    s_cmp_ge_u32 s32, 12
    s_cbranch_scc1 B_helper
    s_add_u32 s96, s58, s40
    s_addc_u32 s97, s59, 0
    s_and_b32 s97, s97, 0xffff
    s_mov_b32 s98, s41
    s_mov_b32 s99, 0x20000
    v_lshlrev_b32 v100, 2, v0
    v_lshlrev_b32 v101, 1, v0
    s_movk_i32 s39, 6144
    buffer_load_dword v104, v100, s[96:99], 0 offen
    buffer_load_dword v105, v100, s[96:99], 0 offen offset:3072
    buffer_load_ushort v106, v101, s[96:99], s39 offen
    v_bfe_u32 v100, v0, 5, 1
    v_bfe_u32 v101, v0, 2, 1
    v_xor_b32 v100, v100, v101
    v_lshlrev_b32 v100, 18, v100
    v_and_b32 v101, 3, v0
    v_lshl_or_b32 v100, v101, 4, v100
    v_bfe_u32 v101, v0, 3, 2
    v_lshl_or_b32 v100, v101, 6, v100
    v_bfe_u32 v101, v0, 5, 1
    v_and_b32 v102, 0xf0, v100
    v_lshl_or_b32 v102, v101, 3, v102
    v_bfe_i32 v119, v0, 2, 1
    v_and_b32 v119, 0xaaaa, v119
    v_or_b32 v119, 0x4444, v119
    s_waitcnt vmcnt(3)
    v_bfe_u32 v45, v45, 8, 22
    v_and_b32 v41, 0xfff, v46
    v_add3_u32 v41, v41, v45, s35
    v_bfe_u32 v27, v46, 12, 15
    v_lshrrev_b32 v26, 6, v41
    v_add_u32 v26, v26, v27
    v_lshl_add_u32 v41, v26, 6, v41
    v_add_u32 v45, s35, v45
    s_nop 0
    v_mov_b32_dpp v24, v41 quad_perm:[0,0,0,0] row_mask:0xf bank_mask:0xf
    buffer_load_dwordx4 v[26:29], v[24:25], s[12:15], 0 idxen offen nt
    v_mov_b32_dpp v24, v41 quad_perm:[1,1,1,1] row_mask:0xf bank_mask:0xf
    buffer_load_dwordx4 v[30:33], v[24:25], s[12:15], 0 idxen offen nt
    s_mov_b64 exec, vcc
    ds_write_b128 v80, v[76:79] offset:7824
    s_mov_b32 exec_lo, 0x03030303
    s_mov_b32 exec_hi, 0x03030303
    ds_write_b64 v126, v[46:47] offset:16
    ds_write_b32 v127, v48 offset:2064
    s_mov_b64 exec, -1
    s_waitcnt lgkmcnt(0)
    s_barrier
    ds_read_b128 v[2:5], v100 offset:7824
    ds_read_b64 v[6:7], v102 offset:8080
    ds_read_b64 v[8:9], v102 offset:8336
    ds_read_b128 v[14:17], v100 offset:8592
    ds_read_b128 v[18:21], v100 offset:8848
    v_lshrrev_b32 v44, 16, v47
    v_and_b32 v47, 0xffff, v47
    v_lshrrev_b32 v46, 27, v46
    v_sub_u32 v44, v45, v44
    v_mad_i32_i24 v47, v45, s6, v47
    v_ashrrev_i32 v44, 31, v44
    v_add_u32 v46, v46, v47
    v_med3_i32 v47, v47, 0, 24
    v_med3_i32 v46, v46, 0, 24
    v_sub_u32 v46, v46, v47
    v_bfm_b32 v46, v46, v47
    v_and_b32 v45, 3, v40
    v_bfi_b32 v46, v44, v46, -1
    v_ashrrev_i32 v44, v45, v46
    v_mul_u32_u24 v127, 96, v0
    v_mov_b32 v90, 0xc166d4ca
    v_mov_b32 v91, 0x41600000
    v_mov_b64 v[56:57], 0
    v_mov_b64 v[58:59], 0
    s_lshl_b32 s24, s68, 16
    s_and_b32 s25, s68, 0xffff0000
    s_lshl_b32 s26, s69, 16
    s_and_b32 s27, s69, 0xffff0000
    s_lshl_b32 s28, s70, 16
    s_and_b32 s29, s70, 0xffff0000
    s_lshl_b32 s30, s71, 16
    s_and_b32 s31, s71, 0xffff0000
    s_setprio 2
    s_waitcnt vmcnt(0)
    s_mov_b64 vcc, s[100:101]
    v_cndmask_b32_dpp v34, v30, v26, vcc quad_perm:[1,0,3,2] row_mask:0xf bank_mask:0xf
    v_cndmask_b32_dpp v35, v31, v27, vcc quad_perm:[1,0,3,2] row_mask:0xf bank_mask:0xf
    v_cndmask_b32_dpp v36, v32, v28, vcc quad_perm:[1,0,3,2] row_mask:0xf bank_mask:0xf
    v_cndmask_b32_dpp v43, v33, v29, vcc quad_perm:[1,0,3,2] row_mask:0xf bank_mask:0xf
    s_not_b64 vcc, vcc
    v_cndmask_b32_dpp v37, v26, v30, vcc quad_perm:[1,0,3,2] row_mask:0xf bank_mask:0xf
    v_cndmask_b32_dpp v38, v27, v31, vcc quad_perm:[1,0,3,2] row_mask:0xf bank_mask:0xf
    v_cndmask_b32_dpp v42, v28, v32, vcc quad_perm:[1,0,3,2] row_mask:0xf bank_mask:0xf
    v_cndmask_b32_dpp v118, v29, v33, vcc quad_perm:[1,0,3,2] row_mask:0xf bank_mask:0xf
    v_bfe_i32 v121, v44, 0, 1
    v_or_b32 v34, v121, v34
    v_bfe_i32 v121, v44, 4, 1
    v_or_b32 v35, v121, v35
    v_and_b32_dpp v22, v34, v1 quad_perm:[0,0,2,2] row_mask:0xf bank_mask:0xf
    buffer_load_dwordx4 v[48:51], v[22:23], s[8:11], 0 idxen offen
    v_and_b32_dpp v22, v34, v1 quad_perm:[1,1,3,3] row_mask:0xf bank_mask:0xf
    buffer_load_dwordx4 v[52:55], v[22:23], s[8:11], 0 idxen offen
    v_lshrrev_b32 v34, 20, v34
    v_mul_u32_u24 v34, 48, v34
    s_setprio 0
    v_bfe_i32 v121, v44, 8, 1
    v_or_b32 v36, v121, v36
    v_bfe_i32 v121, v44, 12, 1
    v_or_b32 v37, v121, v37
    v_bfe_i32 v121, v44, 16, 1
    v_or_b32 v38, v121, v38
    v_lshrrev_b32 v112, 4, v43
    v_lshlrev_b32 v113, 6, v43
    v_lshlrev_b32 v114, 16, v43
    v_lshrrev_b32 v115, 4, v118
    v_lshlrev_b32 v116, 6, v118
    v_lshlrev_b32 v117, 16, v118
    v_lshlrev_b32 v100, 4, v44
    v_bitop3_b32 v100, v43, v118, v100 bitop3:0x54
    v_cmp_gt_i32 vcc, 0, v100
    v_and_b32 v112, 0x3ff0000, v112
    v_and_b32 v113, 0x3ff0000, v113
    v_and_b32 v114, 0x3ff0000, v114
    v_and_b32 v115, 0x3ff0000, v115
    v_and_b32 v116, 0x3ff0000, v116
    v_and_b32 v117, 0x3ff0000, v117
    s_cbranch_vccz B_ang0
    s_call_b64 s[50:51], B_wide
B_ang0:
    v_mul_f32 v101, 0x7cc00000, v112
    v_mul_f32 v100, 0x7aa2f983, v112
    v_cvt_pk_bf16_f32 v101, 0, v101
    v_cos_f32 v100, v100
    v_mul_f32 v101, 0.15915494, v101
    v_cos_f32 v101, v101
    v_fma_mixlo_f16 v124, v100, v100, -0.5
    v_cvt_pk_f16_f32 v123, v100, v101
    ds_write_b128 v127, v[56:59] offset:11200
    ds_write_b128 v127, v[56:59] offset:11216
    v_lshlrev_b32 v108, 16, v104
    v_pk_add_f32 v[76:77], v[108:109], s[24:25] op_sel_hi:[0,1] neg_lo:[0,1] neg_hi:[0,1]
    v_pk_add_f32 v[78:79], v[108:109], s[26:27] op_sel_hi:[0,1] neg_lo:[0,1] neg_hi:[0,1]
    v_pk_add_f32 v[80:81], v[108:109], s[28:29] op_sel_hi:[0,1] neg_lo:[0,1] neg_hi:[0,1]
    v_pk_add_f32 v[82:83], v[108:109], s[30:31] op_sel_hi:[0,1] neg_lo:[0,1] neg_hi:[0,1]
    v_pk_mul_f32 v[76:77], v[76:77], v[76:77]
    v_pk_mul_f32 v[78:79], v[78:79], v[78:79]
    v_pk_mul_f32 v[80:81], v[80:81], v[80:81]
    v_pk_mul_f32 v[82:83], v[82:83], v[82:83]
    v_pk_fma_f32 v[76:77], v[76:77], v[90:91], v[90:91] op_sel:[0,0,1] op_sel_hi:[1,0,1]
    v_pk_fma_f32 v[78:79], v[78:79], v[90:91], v[90:91] op_sel:[0,0,1] op_sel_hi:[1,0,1]
    v_pk_fma_f32 v[80:81], v[80:81], v[90:91], v[90:91] op_sel:[0,0,1] op_sel_hi:[1,0,1]
    v_pk_fma_f32 v[82:83], v[82:83], v[90:91], v[90:91] op_sel:[0,0,1] op_sel_hi:[1,0,1]
    v_exp_f32 v76, v76
    v_exp_f32 v77, v77
    v_exp_f32 v78, v78
    v_exp_f32 v79, v79
    v_exp_f32 v80, v80
    v_exp_f32 v81, v81
    v_exp_f32 v82, v82
    v_exp_f32 v83, v83
    v_cvt_pk_f16_f32 v84, v76, v77
    v_cvt_pk_f16_f32 v85, v78, v79
    v_cvt_pk_f16_f32 v86, v80, v81
    v_cvt_pk_f16_f32 v87, v82, v83
    ds_write_b128 v127, v[84:87] offset:11232
    ds_write_b128 v127, v[56:59] offset:11248
    ds_write_b128 v127, v[56:59] offset:11264
    v_and_b32 v108, 0xffff0000, v104
    v_pk_add_f32 v[76:77], v[108:109], s[24:25] op_sel_hi:[0,1] neg_lo:[0,1] neg_hi:[0,1]
    v_pk_add_f32 v[78:79], v[108:109], s[26:27] op_sel_hi:[0,1] neg_lo:[0,1] neg_hi:[0,1]
    v_pk_add_f32 v[80:81], v[108:109], s[28:29] op_sel_hi:[0,1] neg_lo:[0,1] neg_hi:[0,1]
    v_pk_add_f32 v[82:83], v[108:109], s[30:31] op_sel_hi:[0,1] neg_lo:[0,1] neg_hi:[0,1]
    v_pk_mul_f32 v[76:77], v[76:77], v[76:77]
    v_pk_mul_f32 v[78:79], v[78:79], v[78:79]
    v_pk_mul_f32 v[80:81], v[80:81], v[80:81]
    v_pk_mul_f32 v[82:83], v[82:83], v[82:83]
    v_pk_fma_f32 v[76:77], v[76:77], v[90:91], v[90:91] op_sel:[0,0,1] op_sel_hi:[1,0,1]
    v_pk_fma_f32 v[78:79], v[78:79], v[90:91], v[90:91] op_sel:[0,0,1] op_sel_hi:[1,0,1]
    v_pk_fma_f32 v[80:81], v[80:81], v[90:91], v[90:91] op_sel:[0,0,1] op_sel_hi:[1,0,1]
    v_pk_fma_f32 v[82:83], v[82:83], v[90:91], v[90:91] op_sel:[0,0,1] op_sel_hi:[1,0,1]
    v_exp_f32 v76, v76
    v_exp_f32 v77, v77
    v_exp_f32 v78, v78
    v_exp_f32 v79, v79
    v_exp_f32 v80, v80
    v_exp_f32 v81, v81
    v_exp_f32 v82, v82
    v_exp_f32 v83, v83
    v_cvt_pk_f16_f32 v84, v76, v77
    v_cvt_pk_f16_f32 v85, v78, v79
    v_cvt_pk_f16_f32 v86, v80, v81
    v_cvt_pk_f16_f32 v87, v82, v83
    ds_write_b128 v127, v[84:87] offset:11280
    v_add_u32 v127, 73728, v127
    ds_write_b128 v127, v[56:59] offset:11200
    ds_write_b128 v127, v[56:59] offset:11216
    v_lshlrev_b32 v108, 16, v105
    v_pk_add_f32 v[76:77], v[108:109], s[24:25] op_sel_hi:[0,1] neg_lo:[0,1] neg_hi:[0,1]
    v_pk_add_f32 v[78:79], v[108:109], s[26:27] op_sel_hi:[0,1] neg_lo:[0,1] neg_hi:[0,1]
    v_pk_add_f32 v[80:81], v[108:109], s[28:29] op_sel_hi:[0,1] neg_lo:[0,1] neg_hi:[0,1]
    v_pk_add_f32 v[82:83], v[108:109], s[30:31] op_sel_hi:[0,1] neg_lo:[0,1] neg_hi:[0,1]
    v_pk_mul_f32 v[76:77], v[76:77], v[76:77]
    v_pk_mul_f32 v[78:79], v[78:79], v[78:79]
    v_pk_mul_f32 v[80:81], v[80:81], v[80:81]
    v_pk_mul_f32 v[82:83], v[82:83], v[82:83]
    v_pk_fma_f32 v[76:77], v[76:77], v[90:91], v[90:91] op_sel:[0,0,1] op_sel_hi:[1,0,1]
    v_pk_fma_f32 v[78:79], v[78:79], v[90:91], v[90:91] op_sel:[0,0,1] op_sel_hi:[1,0,1]
    v_pk_fma_f32 v[80:81], v[80:81], v[90:91], v[90:91] op_sel:[0,0,1] op_sel_hi:[1,0,1]
    v_pk_fma_f32 v[82:83], v[82:83], v[90:91], v[90:91] op_sel:[0,0,1] op_sel_hi:[1,0,1]
    v_exp_f32 v76, v76
    v_exp_f32 v77, v77
    v_exp_f32 v78, v78
    v_exp_f32 v79, v79
    v_exp_f32 v80, v80
    v_exp_f32 v81, v81
    v_exp_f32 v82, v82
    v_exp_f32 v83, v83
    v_cvt_pk_f16_f32 v84, v76, v77
    v_cvt_pk_f16_f32 v85, v78, v79
    v_cvt_pk_f16_f32 v86, v80, v81
    v_cvt_pk_f16_f32 v87, v82, v83
    ds_write_b128 v127, v[84:87] offset:11232
    ds_write_b128 v127, v[56:59] offset:11248
    ds_write_b128 v127, v[56:59] offset:11264
    v_and_b32 v108, 0xffff0000, v105
    v_pk_add_f32 v[76:77], v[108:109], s[24:25] op_sel_hi:[0,1] neg_lo:[0,1] neg_hi:[0,1]
    v_pk_add_f32 v[78:79], v[108:109], s[26:27] op_sel_hi:[0,1] neg_lo:[0,1] neg_hi:[0,1]
    v_pk_add_f32 v[80:81], v[108:109], s[28:29] op_sel_hi:[0,1] neg_lo:[0,1] neg_hi:[0,1]
    v_pk_add_f32 v[82:83], v[108:109], s[30:31] op_sel_hi:[0,1] neg_lo:[0,1] neg_hi:[0,1]
    v_pk_mul_f32 v[76:77], v[76:77], v[76:77]
    v_pk_mul_f32 v[78:79], v[78:79], v[78:79]
    v_pk_mul_f32 v[80:81], v[80:81], v[80:81]
    v_pk_mul_f32 v[82:83], v[82:83], v[82:83]
    v_pk_fma_f32 v[76:77], v[76:77], v[90:91], v[90:91] op_sel:[0,0,1] op_sel_hi:[1,0,1]
    v_pk_fma_f32 v[78:79], v[78:79], v[90:91], v[90:91] op_sel:[0,0,1] op_sel_hi:[1,0,1]
    v_pk_fma_f32 v[80:81], v[80:81], v[90:91], v[90:91] op_sel:[0,0,1] op_sel_hi:[1,0,1]
    v_pk_fma_f32 v[82:83], v[82:83], v[90:91], v[90:91] op_sel:[0,0,1] op_sel_hi:[1,0,1]
    v_exp_f32 v76, v76
    v_exp_f32 v77, v77
    v_exp_f32 v78, v78
    v_exp_f32 v79, v79
    v_exp_f32 v80, v80
    v_exp_f32 v81, v81
    v_exp_f32 v82, v82
    v_exp_f32 v83, v83
    v_cvt_pk_f16_f32 v84, v76, v77
    v_cvt_pk_f16_f32 v85, v78, v79
    v_cvt_pk_f16_f32 v86, v80, v81
    v_cvt_pk_f16_f32 v87, v82, v83
    ds_write_b128 v127, v[84:87] offset:11280
    s_setprio 2
    s_waitcnt vmcnt(0) lgkmcnt(3)
    s_cmp_lg_u32 s67, 0
    s_cbranch_scc1 B_rescale
B_rescaled:
    s_mov_b64 vcc, s[100:101]
    v_cndmask_b32_dpp v92, v52, v48, vcc quad_perm:[1,0,3,2] row_mask:0xf bank_mask:0xf
    v_cndmask_b32_dpp v93, v53, v49, vcc quad_perm:[1,0,3,2] row_mask:0xf bank_mask:0xf
    v_cndmask_b32_dpp v94, v54, v50, vcc quad_perm:[1,0,3,2] row_mask:0xf bank_mask:0xf
    v_cndmask_b32_dpp v95, v55, v51, vcc quad_perm:[1,0,3,2] row_mask:0xf bank_mask:0xf
    s_not_b64 vcc, vcc
    v_cndmask_b32_dpp v96, v48, v52, vcc quad_perm:[1,0,3,2] row_mask:0xf bank_mask:0xf
    v_cndmask_b32_dpp v97, v49, v53, vcc quad_perm:[1,0,3,2] row_mask:0xf bank_mask:0xf
    v_cndmask_b32_dpp v98, v50, v54, vcc quad_perm:[1,0,3,2] row_mask:0xf bank_mask:0xf
    v_cndmask_b32_dpp v99, v51, v55, vcc quad_perm:[1,0,3,2] row_mask:0xf bank_mask:0xf
    v_and_b32_dpp v22, v35, v1 quad_perm:[0,0,2,2] row_mask:0xf bank_mask:0xf
    buffer_load_dwordx4 v[48:51], v[22:23], s[8:11], 0 idxen offen
    v_and_b32_dpp v22, v35, v1 quad_perm:[1,1,3,3] row_mask:0xf bank_mask:0xf
    buffer_load_dwordx4 v[52:55], v[22:23], s[8:11], 0 idxen offen
    v_lshrrev_b32 v35, 20, v35
    v_mul_u32_u24 v35, 48, v35
    s_setprio 0
    v_mfma_f32_32x32x16_bf16 v[60:75], v[14:17], v[92:95], 0
    s_nop 0
    v_mfma_f32_32x32x16_bf16 v[60:75], v[18:21], v[96:99], v[60:75]
    s_cmp_ge_u32 s32, 2
    s_cbranch_scc1 B_join
    v_add_u32 v127, 3072, v0
    v_mul_u32_u24 v127, 48, v127
    ds_write_b128 v127, v[56:59] offset:11200
    ds_write_b128 v127, v[56:59] offset:11216
    v_lshlrev_b32 v108, 16, v106
    v_pk_add_f32 v[76:77], v[108:109], s[24:25] op_sel_hi:[0,1] neg_lo:[0,1] neg_hi:[0,1]
    v_pk_add_f32 v[78:79], v[108:109], s[26:27] op_sel_hi:[0,1] neg_lo:[0,1] neg_hi:[0,1]
    v_pk_add_f32 v[80:81], v[108:109], s[28:29] op_sel_hi:[0,1] neg_lo:[0,1] neg_hi:[0,1]
    v_pk_add_f32 v[82:83], v[108:109], s[30:31] op_sel_hi:[0,1] neg_lo:[0,1] neg_hi:[0,1]
    v_pk_mul_f32 v[76:77], v[76:77], v[76:77]
    v_pk_mul_f32 v[78:79], v[78:79], v[78:79]
    v_pk_mul_f32 v[80:81], v[80:81], v[80:81]
    v_pk_mul_f32 v[82:83], v[82:83], v[82:83]
    v_pk_fma_f32 v[76:77], v[76:77], v[90:91], v[90:91] op_sel:[0,0,1] op_sel_hi:[1,0,1]
    v_pk_fma_f32 v[78:79], v[78:79], v[90:91], v[90:91] op_sel:[0,0,1] op_sel_hi:[1,0,1]
    v_pk_fma_f32 v[80:81], v[80:81], v[90:91], v[90:91] op_sel:[0,0,1] op_sel_hi:[1,0,1]
    v_pk_fma_f32 v[82:83], v[82:83], v[90:91], v[90:91] op_sel:[0,0,1] op_sel_hi:[1,0,1]
    v_exp_f32 v76, v76
    v_exp_f32 v77, v77
    v_exp_f32 v78, v78
    v_exp_f32 v79, v79
    v_exp_f32 v80, v80
    v_exp_f32 v81, v81
    v_exp_f32 v82, v82
    v_exp_f32 v83, v83
    v_cvt_pk_f16_f32 v84, v76, v77
    v_cvt_pk_f16_f32 v85, v78, v79
    v_cvt_pk_f16_f32 v86, v80, v81
    v_cvt_pk_f16_f32 v87, v82, v83
    ds_write_b128 v127, v[84:87] offset:11232
B_join:
    v_mov_b32 v126, 0
    s_waitcnt lgkmcnt(0)
    s_barrier
    ds_read_b128 v[56:59], v34 offset:11232
    ds_read_b64 v[46:47], v126 offset:8
    s_waitcnt lgkmcnt(0)
    v_readfirstlane_b32 s33, v46
    v_readfirstlane_b32 s37, v47
    s_cmp_ge_u32 s33, 192
    s_cselect_b32 s39, 192, 0
    s_sub_u32 s42, s33, s39
    s_add_u32 s43, s33, s39
    v_pk_mul_f16 v100, v56, v123 op_sel:[0,0] op_sel_hi:[1,0]
    v_pk_mul_f16 v101, v57, v123 op_sel:[0,0] op_sel_hi:[1,0]
    v_pk_mul_f16 v102, v58, v123 op_sel:[0,0] op_sel_hi:[1,0]
    v_pk_mul_f16 v103, v59, v123 op_sel:[0,0] op_sel_hi:[1,0]
    v_pk_mul_f16 v92, v56, v124 op_sel:[0,0] op_sel_hi:[1,0]
    v_pk_mul_f16 v93, v56, v123 op_sel:[0,1] op_sel_hi:[1,1]
    v_pk_mul_f16 v94, v57, v124 op_sel:[0,0] op_sel_hi:[1,0]
    v_pk_mul_f16 v95, v57, v123 op_sel:[0,1] op_sel_hi:[1,1]
    v_mfma_f32_32x32x16_f16 v[76:91], v[2:5], v[100:103], 0
    v_pk_mul_f16 v96, v58, v124 op_sel:[0,0] op_sel_hi:[1,0]
    v_pk_mul_f16 v97, v58, v123 op_sel:[0,1] op_sel_hi:[1,1]
    v_pk_mul_f16 v98, v59, v124 op_sel:[0,0] op_sel_hi:[1,0]
    v_pk_mul_f16 v99, v59, v123 op_sel:[0,1] op_sel_hi:[1,1]
    v_permlane32_swap_b32 v92, v93
    v_permlane32_swap_b32 v94, v95
    v_permlane32_swap_b32 v96, v97
    v_permlane32_swap_b32 v98, v99
    s_nop 1
    v_smfmac_f32_32x32x32_f16 v[76:91], v[6:9], v[92:99], v119
    s_nop 4
    s_branch B_mid
B_helper:
    s_mul_i32 s66, s2, 4
    s_add_u32 s66, s66, s32
    s_add_u32 s66, s66, 65524
    s_lshl_b32 s66, s66, 7
    s_add_u32 s66, s66, 60
    s_waitcnt vmcnt(0)
    s_mov_b32 exec_lo, 0x03030303
    s_mov_b32 exec_hi, 0x03030303
    ds_write_b64 v126, v[46:47] offset:16
    ds_write_b32 v127, v48 offset:2064
    s_mov_b64 exec, -1
    s_waitcnt lgkmcnt(0)
    s_barrier
B_list:
    s_setprio 1
    v_lshlrev_b32 v126, 3, v125
    v_lshlrev_b32 v127, 2, v125
    ds_read_u16 v60, v126 offset:22
    ds_read_b32 v64, v127 offset:2064
    v_add_u32 v72, 0, v125
    ds_read_u16 v61, v126 offset:534
    ds_read_b32 v65, v127 offset:2320
    v_add_u32 v73, 64, v125
    ds_read_u16 v62, v126 offset:1046
    ds_read_b32 v66, v127 offset:2576
    v_add_u32 v74, 128, v125
    ds_read_u16 v63, v126 offset:1558
    ds_read_b32 v67, v127 offset:2832
    v_add_u32 v75, 192, v125
    s_cmp_lg_u32 s36, 0
    s_waitcnt lgkmcnt(0)
    s_cbranch_scc1 B_generic
    v_add_u32 v76, v60, v61
    v_add3_u32 v76, v76, v62, v63
    v_bcnt_u32_b32 v77, v64, 0
    v_bcnt_u32_b32 v77, v65, v77
    v_bcnt_u32_b32 v77, v66, v77
    v_bcnt_u32_b32 v77, v67, v77
    v_cmp_ne_u32 vcc, v76, v77
    s_mov_b32 s37, 1
    s_cbranch_vccz B_count
B_generic0:
    v_max_u32 v76, v60, v61
    v_max3_u32 v76, v76, v62, v63
    s_nop 1
    v_max_u32_dpp v76, v76, v76 row_shr:1 row_mask:0xf bank_mask:0xf bound_ctrl:1
    s_nop 1
    v_max_u32_dpp v76, v76, v76 row_shr:2 row_mask:0xf bank_mask:0xf bound_ctrl:1
    s_nop 1
    v_max_u32_dpp v76, v76, v76 row_shr:4 row_mask:0xf bank_mask:0xf bound_ctrl:1
    s_nop 1
    v_max_u32_dpp v76, v76, v76 row_shr:8 row_mask:0xf bank_mask:0xf bound_ctrl:1
    s_nop 1
    v_max_u32_dpp v76, v76, v76 row_bcast:15 row_mask:0xa bank_mask:0xf
    s_nop 1
    v_max_u32_dpp v76, v76, v76 row_bcast:31 row_mask:0xc bank_mask:0xf
    s_nop 0
    v_readlane_b32 s37, v76, 63
    s_add_u32 s37, s37, 8
    s_mul_i32 s37, s37, 116509
    s_lshr_b32 s37, s37, 20
B_generic:
    v_subrev_u32 v77, s35, v60
    v_med3_i32 v77, v77, 0, 9
    v_bfm_b32 v64, v77, 0
    v_subrev_u32 v77, s35, v61
    v_med3_i32 v77, v77, 0, 9
    v_bfm_b32 v65, v77, 0
    v_subrev_u32 v77, s35, v62
    v_med3_i32 v77, v77, 0, 9
    v_bfm_b32 v66, v77, 0
    v_subrev_u32 v77, s35, v63
    v_med3_i32 v77, v77, 0, 9
    v_bfm_b32 v67, v77, 0
B_count:
    v_add_u32 v77, -1, v64
    v_and_b32 v64, v77, v64
    v_or_b32 v72, 0x100, v72
    v_add_u32 v77, -1, v65
    v_and_b32 v65, v77, v65
    v_or_b32 v73, 0x100, v73
    v_add_u32 v77, -1, v66
    v_and_b32 v66, v77, v66
    v_or_b32 v74, 0x100, v74
    v_bcnt_u32_b32 v76, v64, 0
    v_bcnt_u32_b32 v76, v65, v76
    v_bcnt_u32_b32 v76, v66, v76
    v_bcnt_u32_b32 v76, v67, v76
    s_nop 1
    v_add_u32_dpp v76, v76, v76 row_shr:1 row_mask:0xf bank_mask:0xf bound_ctrl:1
    s_nop 1
    v_add_u32_dpp v76, v76, v76 row_shr:2 row_mask:0xf bank_mask:0xf bound_ctrl:1
    s_nop 1
    v_add_u32_dpp v76, v76, v76 row_shr:4 row_mask:0xf bank_mask:0xf bound_ctrl:1
    s_nop 1
    v_add_u32_dpp v76, v76, v76 row_shr:8 row_mask:0xf bank_mask:0xf bound_ctrl:1
    s_nop 1
    v_add_u32_dpp v76, v76, v76 row_bcast:15 row_mask:0xa bank_mask:0xf
    s_nop 1
    v_add_u32_dpp v76, v76, v76 row_bcast:31 row_mask:0xc bank_mask:0xf
    v_or_b32 v77, v64, v65
    v_readlane_b32 s33, v76, 63
    v_or3_b32 v78, v77, v66, v67
    s_cmp_gt_u32 s33, 2304
    s_cbranch_scc1 B_generic0
    s_sub_u32 s41, s32, 12
    s_mul_i32 s41, s41, 7
    s_add_u32 s40, s41, 7
    s_cmp_lg_u32 s32, 15
    s_cbranch_scc1 B_bits
    s_mov_b32 s40, 32
    s_add_u32 s39, s33, 15
    s_lshr_b32 s39, s39, 4
    s_lshl_b32 s39, s39, 6
    v_mov_b32 v76, 0x8000
    v_add_u32 v77, s33, v125
    v_lshlrev_b32 v77, 1, v77
    v_mov_b32 v126, 0
    v_mov_b32 v80, s39
    v_mov_b32 v81, s37
    ds_write_b16 v77, v76 offset:3088
    ds_write2_b32 v126, v126, v126 offset0:0 offset1:1
    ds_write_b64 v126, v[80:81] offset:8
B_bits:
    s_bfm_b32 s44, s41, 0
    v_and_b32 v68, s44, v64
    v_bcnt_u32_b32 v68, v68, 0
    v_and_b32 v69, s44, v65
    v_bcnt_u32_b32 v69, v69, 0
    v_and_b32 v70, s44, v66
    v_bcnt_u32_b32 v70, v70, 0
    v_and_b32 v71, s44, v67
    v_bcnt_u32_b32 v71, v71, 0
    v_add_u32 v76, v68, v69
    v_add3_u32 v76, v76, v70, v71
    v_lshl_add_u32 v72, v68, 8, v72
    v_lshl_add_u32 v73, v69, 8, v73
    v_lshl_add_u32 v74, v70, 8, v74
    v_lshl_add_u32 v75, v71, 8, v75
    s_nop 1
    v_add_u32_dpp v76, v76, v76 row_shr:1 row_mask:0xf bank_mask:0xf bound_ctrl:1
    s_nop 1
    v_add_u32_dpp v76, v76, v76 row_shr:2 row_mask:0xf bank_mask:0xf bound_ctrl:1
    s_nop 1
    v_add_u32_dpp v76, v76, v76 row_shr:4 row_mask:0xf bank_mask:0xf bound_ctrl:1
    s_nop 1
    v_add_u32_dpp v76, v76, v76 row_shr:8 row_mask:0xf bank_mask:0xf bound_ctrl:1
    s_nop 1
    v_add_u32_dpp v76, v76, v76 row_bcast:15 row_mask:0xa bank_mask:0xf
    s_nop 1
    v_add_u32_dpp v76, v76, v76 row_bcast:31 row_mask:0xc bank_mask:0xf
    s_nop 0
    v_readlane_b32 s42, v76, 63
B_bit:
    s_lshl_b32 s43, 1, s41
    v_and_b32 v76, s43, v78
    v_cmp_ne_u32 vcc, 0, v76
    s_cbranch_vccz B_bit_next
    v_and_b32 v68, s43, v64
    v_and_b32 v69, s43, v65
    v_and_b32 v70, s43, v66
    v_and_b32 v71, s43, v67
    v_cmp_ne_u32 s[24:25], 0, v68
    v_cmp_ne_u32 s[26:27], 0, v69
    v_cmp_ne_u32 s[28:29], 0, v70
    v_cmp_ne_u32 s[30:31], 0, v71
    v_mbcnt_lo_u32_b32 v76, s24, 0
    v_mbcnt_hi_u32_b32 v76, s25, v76
    s_mov_b64 exec, s[24:25]
    v_add_lshl_u32 v76, v76, s42, 1
    s_bcnt1_i32_b64 s39, s[24:25]
    ds_write_b16 v76, v72 offset:3088
    v_add_u32 v72, 0x100, v72
    s_add_u32 s42, s42, s39
    s_mov_b64 exec, -1
    v_mbcnt_lo_u32_b32 v76, s26, 0
    v_mbcnt_hi_u32_b32 v76, s27, v76
    s_mov_b64 exec, s[26:27]
    v_add_lshl_u32 v76, v76, s42, 1
    s_bcnt1_i32_b64 s39, s[26:27]
    ds_write_b16 v76, v73 offset:3088
    v_add_u32 v73, 0x100, v73
    s_add_u32 s42, s42, s39
    s_mov_b64 exec, -1
    v_mbcnt_lo_u32_b32 v76, s28, 0
    v_mbcnt_hi_u32_b32 v76, s29, v76
    s_mov_b64 exec, s[28:29]
    v_add_lshl_u32 v76, v76, s42, 1
    s_bcnt1_i32_b64 s39, s[28:29]
    ds_write_b16 v76, v74 offset:3088
    v_add_u32 v74, 0x100, v74
    s_add_u32 s42, s42, s39
    s_mov_b64 exec, -1
    v_mbcnt_lo_u32_b32 v76, s30, 0
    v_mbcnt_hi_u32_b32 v76, s31, v76
    s_mov_b64 exec, s[30:31]
    v_add_lshl_u32 v76, v76, s42, 1
    s_bcnt1_i32_b64 s39, s[30:31]
    ds_write_b16 v76, v75 offset:3088
    v_add_u32 v75, 0x100, v75
    s_add_u32 s42, s42, s39
    s_mov_b64 exec, -1
B_bit_next:
    s_add_u32 s41, s41, 1
    s_cmp_lt_u32 s41, s40
    s_cbranch_scc1 B_bit
    s_setprio 0
    s_waitcnt vmcnt(0) lgkmcnt(0)
    s_barrier
    s_mov_b32 s20, s56
    s_and_b32 s21, s57, 0xffff
    s_mov_b32 s22, 25600000
    s_mov_b32 s23, 0x20000
B_help:
    s_buffer_load_dwordx2 s[94:95], s[20:23], s66
    s_add_u32 s66, s66, 131072
    s_min_u32 s66, s66, 25599932
    s_buffer_load_dwordx2 s[94:95], s[20:23], s66
    s_add_u32 s66, s66, 131072
    s_min_u32 s66, s66, 25599932
    s_buffer_load_dwordx2 s[94:95], s[20:23], s66
    s_add_u32 s66, s66, 131072
    s_min_u32 s66, s66, 25599932
    s_buffer_load_dwordx2 s[94:95], s[20:23], s66
    s_add_u32 s66, s66, 131072
    s_min_u32 s66, s66, 25599932
    s_cmp_lt_u32 s66, 25599932
    s_waitcnt lgkmcnt(0)
    s_cbranch_scc1 B_help
    s_branch B_loop_done
B_loop:
    s_waitcnt vmcnt(0)
    s_mov_b64 vcc, s[100:101]
    v_cndmask_b32_dpp v92, v52, v48, vcc quad_perm:[1,0,3,2] row_mask:0xf bank_mask:0xf
    v_cndmask_b32_dpp v93, v53, v49, vcc quad_perm:[1,0,3,2] row_mask:0xf bank_mask:0xf
    v_cndmask_b32_dpp v94, v54, v50, vcc quad_perm:[1,0,3,2] row_mask:0xf bank_mask:0xf
    v_cndmask_b32_dpp v95, v55, v51, vcc quad_perm:[1,0,3,2] row_mask:0xf bank_mask:0xf
    s_not_b64 vcc, vcc
    v_cndmask_b32_dpp v96, v48, v52, vcc quad_perm:[1,0,3,2] row_mask:0xf bank_mask:0xf
    v_cndmask_b32_dpp v97, v49, v53, vcc quad_perm:[1,0,3,2] row_mask:0xf bank_mask:0xf
    v_cndmask_b32_dpp v98, v50, v54, vcc quad_perm:[1,0,3,2] row_mask:0xf bank_mask:0xf
    v_cndmask_b32_dpp v99, v51, v55, vcc quad_perm:[1,0,3,2] row_mask:0xf bank_mask:0xf
    v_mfma_f32_32x32x16_bf16 v[60:75], v[14:17], v[92:95], 0
    s_nop 0
    v_mfma_f32_32x32x16_bf16 v[60:75], v[18:21], v[96:99], v[60:75]
    v_and_b32_dpp v22, v35, v1 quad_perm:[0,0,2,2] row_mask:0xf bank_mask:0xf
    buffer_load_dwordx4 v[48:51], v[22:23], s[8:11], 0 idxen offen
    v_and_b32_dpp v22, v35, v1 quad_perm:[1,1,3,3] row_mask:0xf bank_mask:0xf
    buffer_load_dwordx4 v[52:55], v[22:23], s[8:11], 0 idxen offen
    v_lshrrev_b32 v35, 20, v35
    v_mul_u32_u24 v35, 48, v35
B_mid:
    v_mul_f32 v101, 0x7cc00000, v113
    v_mul_f32 v100, 0x7aa2f983, v113
    v_cvt_pk_bf16_f32 v101, 0, v101
    v_cos_f32 v100, v100
    v_mul_f32 v101, 0.15915494, v101
    v_cos_f32 v101, v101
    v_fma_mixlo_f16 v124, v100, v100, -0.5
    v_cvt_pk_f16_f32 v123, v100, v101
    v_pk_mul_f32 v[76:77], v[60:61], v[76:77]
    v_pk_mul_f32 v[78:79], v[62:63], v[78:79]
    v_pk_mul_f32 v[80:81], v[64:65], v[80:81]
    v_pk_mul_f32 v[82:83], v[66:67], v[82:83]
    v_pk_mul_f32 v[84:85], v[68:69], v[84:85]
    v_pk_mul_f32 v[86:87], v[70:71], v[86:87]
    v_pk_mul_f32 v[88:89], v[72:73], v[88:89]
    v_pk_mul_f32 v[90:91], v[74:75], v[90:91]
    s_setprio 2
    ds_wrxchg_rtn_b32 v121, v34, v122 offset:11200
    ds_read_b128 v[96:99], v34 offset:11216
    ds_read_b128 v[92:95], v34 offset:11200
    ds_read_b128 v[56:59], v35 offset:11232
    v_cvt_pk_f16_f32 v60, v76, v77
    v_cvt_pk_f16_f32 v61, v78, v79
    v_cvt_pk_f16_f32 v62, v80, v81
    v_cvt_pk_f16_f32 v63, v82, v83
    v_cvt_pk_f16_f32 v64, v84, v85
    v_cvt_pk_f16_f32 v65, v86, v87
    v_cvt_pk_f16_f32 v66, v88, v89
    v_cvt_pk_f16_f32 v67, v90, v91
    s_waitcnt lgkmcnt(1)
    v_cmp_ne_u32 vcc, v121, v122
    s_mov_b64 exec, vcc
    v_pk_add_f16 v96, v96, v64
    v_pk_add_f16 v97, v97, v65
    v_pk_add_f16 v98, v98, v66
    v_pk_add_f16 v99, v99, v67
    ds_write_b128 v34, v[96:99] offset:11216
    v_pk_add_f16 v92, v121, v60
    v_pk_add_f16 v93, v93, v61
    v_pk_add_f16 v94, v94, v62
    v_pk_add_f16 v95, v95, v63
    ds_write_b128 v34, v[92:95] offset:11200
    s_setprio 0
    s_not_b64 s[48:49], vcc
    s_cbranch_scc0 B_nolose0
    s_and_b64 s[54:55], s[48:49], s[46:47]
    s_cbranch_scc0 B_stash0
    s_call_b64 s[50:51], B_drain
B_stash0:
    s_mov_b64 exec, s[48:49]
    s_or_b64 s[46:47], s[46:47], s[48:49]
    v_mov_b64 v[104:105], v[60:61]
    v_mov_b64 v[106:107], v[62:63]
    v_mov_b64 v[108:109], v[64:65]
    v_mov_b64 v[110:111], v[66:67]
    v_mov_b32 v120, v34
B_nolose0:
    s_mov_b64 exec, -1
    v_bfe_i32 v121, v44, 20, 1
    v_or_b32 v39, v121, v42
    s_waitcnt lgkmcnt(2)
    v_pk_mul_f16 v100, v56, v123 op_sel:[0,0] op_sel_hi:[1,0]
    v_pk_mul_f16 v101, v57, v123 op_sel:[0,0] op_sel_hi:[1,0]
    v_pk_mul_f16 v102, v58, v123 op_sel:[0,0] op_sel_hi:[1,0]
    v_pk_mul_f16 v103, v59, v123 op_sel:[0,0] op_sel_hi:[1,0]
    v_pk_mul_f16 v92, v56, v124 op_sel:[0,0] op_sel_hi:[1,0]
    v_pk_mul_f16 v93, v56, v123 op_sel:[0,1] op_sel_hi:[1,1]
    v_pk_mul_f16 v94, v57, v124 op_sel:[0,0] op_sel_hi:[1,0]
    v_pk_mul_f16 v95, v57, v123 op_sel:[0,1] op_sel_hi:[1,1]
    v_mfma_f32_32x32x16_f16 v[76:91], v[2:5], v[100:103], 0
    v_pk_mul_f16 v96, v58, v124 op_sel:[0,0] op_sel_hi:[1,0]
    v_pk_mul_f16 v97, v58, v123 op_sel:[0,1] op_sel_hi:[1,1]
    v_pk_mul_f16 v98, v59, v124 op_sel:[0,0] op_sel_hi:[1,0]
    v_pk_mul_f16 v99, v59, v123 op_sel:[0,1] op_sel_hi:[1,1]
    v_permlane32_swap_b32 v92, v93
    v_permlane32_swap_b32 v94, v95
    v_permlane32_swap_b32 v96, v97
    v_permlane32_swap_b32 v98, v99
    s_nop 1
    v_smfmac_f32_32x32x32_f16 v[76:91], v[6:9], v[92:99], v119
    s_waitcnt vmcnt(0)
    s_mov_b64 vcc, s[100:101]
    v_cndmask_b32_dpp v92, v52, v48, vcc quad_perm:[1,0,3,2] row_mask:0xf bank_mask:0xf
    v_cndmask_b32_dpp v93, v53, v49, vcc quad_perm:[1,0,3,2] row_mask:0xf bank_mask:0xf
    v_cndmask_b32_dpp v94, v54, v50, vcc quad_perm:[1,0,3,2] row_mask:0xf bank_mask:0xf
    v_cndmask_b32_dpp v95, v55, v51, vcc quad_perm:[1,0,3,2] row_mask:0xf bank_mask:0xf
    s_not_b64 vcc, vcc
    v_cndmask_b32_dpp v96, v48, v52, vcc quad_perm:[1,0,3,2] row_mask:0xf bank_mask:0xf
    v_cndmask_b32_dpp v97, v49, v53, vcc quad_perm:[1,0,3,2] row_mask:0xf bank_mask:0xf
    v_cndmask_b32_dpp v98, v50, v54, vcc quad_perm:[1,0,3,2] row_mask:0xf bank_mask:0xf
    v_cndmask_b32_dpp v99, v51, v55, vcc quad_perm:[1,0,3,2] row_mask:0xf bank_mask:0xf
    v_mfma_f32_32x32x16_bf16 v[60:75], v[14:17], v[92:95], 0
    s_nop 0
    v_mfma_f32_32x32x16_bf16 v[60:75], v[18:21], v[96:99], v[60:75]
    v_and_b32_dpp v22, v36, v1 quad_perm:[0,0,2,2] row_mask:0xf bank_mask:0xf
    buffer_load_dwordx4 v[48:51], v[22:23], s[8:11], 0 idxen offen
    v_and_b32_dpp v22, v36, v1 quad_perm:[1,1,3,3] row_mask:0xf bank_mask:0xf
    buffer_load_dwordx4 v[52:55], v[22:23], s[8:11], 0 idxen offen
    v_lshrrev_b32 v36, 20, v36
    v_mul_u32_u24 v36, 48, v36
    s_cmp_eq_u32 s44, 0x60
    s_cselect_b64 exec, -1, 0
    ds_append v45 offset:0
    s_mov_b64 exec, -1
    v_mul_f32 v101, 0x7cc00000, v114
    v_mul_f32 v100, 0x7aa2f983, v114
    v_cvt_pk_bf16_f32 v101, 0, v101
    v_cos_f32 v100, v100
    v_mul_f32 v101, 0.15915494, v101
    v_cos_f32 v101, v101
    v_fma_mixlo_f16 v124, v100, v100, -0.5
    v_cvt_pk_f16_f32 v123, v100, v101
    v_pk_mul_f32 v[76:77], v[60:61], v[76:77]
    v_pk_mul_f32 v[78:79], v[62:63], v[78:79]
    v_pk_mul_f32 v[80:81], v[64:65], v[80:81]
    v_pk_mul_f32 v[82:83], v[66:67], v[82:83]
    v_pk_mul_f32 v[84:85], v[68:69], v[84:85]
    v_pk_mul_f32 v[86:87], v[70:71], v[86:87]
    v_pk_mul_f32 v[88:89], v[72:73], v[88:89]
    v_pk_mul_f32 v[90:91], v[74:75], v[90:91]
    s_setprio 2
    ds_wrxchg_rtn_b32 v121, v35, v122 offset:11200
    ds_read_b128 v[96:99], v35 offset:11216
    ds_read_b128 v[92:95], v35 offset:11200
    ds_read_b128 v[56:59], v36 offset:11232
    v_cvt_pk_f16_f32 v60, v76, v77
    v_cvt_pk_f16_f32 v61, v78, v79
    v_cvt_pk_f16_f32 v62, v80, v81
    v_cvt_pk_f16_f32 v63, v82, v83
    v_cvt_pk_f16_f32 v64, v84, v85
    v_cvt_pk_f16_f32 v65, v86, v87
    v_cvt_pk_f16_f32 v66, v88, v89
    v_cvt_pk_f16_f32 v67, v90, v91
    s_waitcnt lgkmcnt(1)
    v_cmp_ne_u32 vcc, v121, v122
    s_mov_b64 exec, vcc
    v_pk_add_f16 v96, v96, v64
    v_pk_add_f16 v97, v97, v65
    v_pk_add_f16 v98, v98, v66
    v_pk_add_f16 v99, v99, v67
    ds_write_b128 v35, v[96:99] offset:11216
    v_pk_add_f16 v92, v121, v60
    v_pk_add_f16 v93, v93, v61
    v_pk_add_f16 v94, v94, v62
    v_pk_add_f16 v95, v95, v63
    ds_write_b128 v35, v[92:95] offset:11200
    s_setprio 0
    s_not_b64 s[48:49], vcc
    s_cbranch_scc0 B_nolose1
    s_and_b64 s[54:55], s[48:49], s[46:47]
    s_cbranch_scc0 B_stash1
    s_call_b64 s[50:51], B_drain
B_stash1:
    s_mov_b64 exec, s[48:49]
    s_or_b64 s[46:47], s[46:47], s[48:49]
    v_mov_b64 v[104:105], v[60:61]
    v_mov_b64 v[106:107], v[62:63]
    v_mov_b64 v[108:109], v[64:65]
    v_mov_b64 v[110:111], v[66:67]
    v_mov_b32 v120, v35
B_nolose1:
    s_mov_b64 exec, -1
    s_waitcnt lgkmcnt(2)
    v_pk_mul_f16 v100, v56, v123 op_sel:[0,0] op_sel_hi:[1,0]
    v_pk_mul_f16 v101, v57, v123 op_sel:[0,0] op_sel_hi:[1,0]
    v_pk_mul_f16 v102, v58, v123 op_sel:[0,0] op_sel_hi:[1,0]
    v_pk_mul_f16 v103, v59, v123 op_sel:[0,0] op_sel_hi:[1,0]
    v_pk_mul_f16 v92, v56, v124 op_sel:[0,0] op_sel_hi:[1,0]
    v_pk_mul_f16 v93, v56, v123 op_sel:[0,1] op_sel_hi:[1,1]
    v_pk_mul_f16 v94, v57, v124 op_sel:[0,0] op_sel_hi:[1,0]
    v_pk_mul_f16 v95, v57, v123 op_sel:[0,1] op_sel_hi:[1,1]
    v_mfma_f32_32x32x16_f16 v[76:91], v[2:5], v[100:103], 0
    v_pk_mul_f16 v96, v58, v124 op_sel:[0,0] op_sel_hi:[1,0]
    v_pk_mul_f16 v97, v58, v123 op_sel:[0,1] op_sel_hi:[1,1]
    v_pk_mul_f16 v98, v59, v124 op_sel:[0,0] op_sel_hi:[1,0]
    v_pk_mul_f16 v99, v59, v123 op_sel:[0,1] op_sel_hi:[1,1]
    v_permlane32_swap_b32 v92, v93
    v_permlane32_swap_b32 v94, v95
    v_permlane32_swap_b32 v96, v97
    v_permlane32_swap_b32 v98, v99
    s_nop 1
    v_smfmac_f32_32x32x32_f16 v[76:91], v[6:9], v[92:99], v119
    s_waitcnt vmcnt(0)
    s_mov_b64 vcc, s[100:101]
    v_cndmask_b32_dpp v92, v52, v48, vcc quad_perm:[1,0,3,2] row_mask:0xf bank_mask:0xf
    v_cndmask_b32_dpp v93, v53, v49, vcc quad_perm:[1,0,3,2] row_mask:0xf bank_mask:0xf
    v_cndmask_b32_dpp v94, v54, v50, vcc quad_perm:[1,0,3,2] row_mask:0xf bank_mask:0xf
    v_cndmask_b32_dpp v95, v55, v51, vcc quad_perm:[1,0,3,2] row_mask:0xf bank_mask:0xf
    s_not_b64 vcc, vcc
    v_cndmask_b32_dpp v96, v48, v52, vcc quad_perm:[1,0,3,2] row_mask:0xf bank_mask:0xf
    v_cndmask_b32_dpp v97, v49, v53, vcc quad_perm:[1,0,3,2] row_mask:0xf bank_mask:0xf
    v_cndmask_b32_dpp v98, v50, v54, vcc quad_perm:[1,0,3,2] row_mask:0xf bank_mask:0xf
    v_cndmask_b32_dpp v99, v51, v55, vcc quad_perm:[1,0,3,2] row_mask:0xf bank_mask:0xf
    v_mfma_f32_32x32x16_bf16 v[60:75], v[14:17], v[92:95], 0
    s_nop 0
    v_mfma_f32_32x32x16_bf16 v[60:75], v[18:21], v[96:99], v[60:75]
    v_and_b32_dpp v22, v37, v1 quad_perm:[0,0,2,2] row_mask:0xf bank_mask:0xf
    buffer_load_dwordx4 v[48:51], v[22:23], s[8:11], 0 idxen offen
    v_and_b32_dpp v22, v37, v1 quad_perm:[1,1,3,3] row_mask:0xf bank_mask:0xf
    buffer_load_dwordx4 v[52:55], v[22:23], s[8:11], 0 idxen offen
    v_lshrrev_b32 v37, 20, v37
    v_mul_u32_u24 v37, 48, v37
    v_readfirstlane_b32 s34, v45
    v_and_or_b32 v45, v40, 60, v45
    s_cmp_ge_u32 s34, s42
    s_cbranch_scc1 B_hent
B_hent_done:
    v_lshrrev_b32 v45, 1, v45
    ds_read_i16 v45, v45 offset:3088
    v_mul_f32 v101, 0x7cc00000, v115
    v_mul_f32 v100, 0x7aa2f983, v115
    v_cvt_pk_bf16_f32 v101, 0, v101
    v_cos_f32 v100, v100
    v_mul_f32 v101, 0.15915494, v101
    v_cos_f32 v101, v101
    v_fma_mixlo_f16 v124, v100, v100, -0.5
    v_cvt_pk_f16_f32 v123, v100, v101
    v_pk_mul_f32 v[76:77], v[60:61], v[76:77]
    v_pk_mul_f32 v[78:79], v[62:63], v[78:79]
    v_pk_mul_f32 v[80:81], v[64:65], v[80:81]
    v_pk_mul_f32 v[82:83], v[66:67], v[82:83]
    v_pk_mul_f32 v[84:85], v[68:69], v[84:85]
    v_pk_mul_f32 v[86:87], v[70:71], v[86:87]
    v_pk_mul_f32 v[88:89], v[72:73], v[88:89]
    v_pk_mul_f32 v[90:91], v[74:75], v[90:91]
    s_setprio 2
    ds_wrxchg_rtn_b32 v121, v36, v122 offset:11200
    ds_read_b128 v[96:99], v36 offset:11216
    ds_read_b128 v[92:95], v36 offset:11200
    ds_read_b128 v[56:59], v37 offset:11232
    v_cvt_pk_f16_f32 v60, v76, v77
    v_cvt_pk_f16_f32 v61, v78, v79
    v_cvt_pk_f16_f32 v62, v80, v81
    v_cvt_pk_f16_f32 v63, v82, v83
    v_cvt_pk_f16_f32 v64, v84, v85
    v_cvt_pk_f16_f32 v65, v86, v87
    v_cvt_pk_f16_f32 v66, v88, v89
    v_cvt_pk_f16_f32 v67, v90, v91
    s_waitcnt lgkmcnt(1)
    v_cmp_ne_u32 vcc, v121, v122
    s_mov_b64 exec, vcc
    v_pk_add_f16 v96, v96, v64
    v_pk_add_f16 v97, v97, v65
    v_pk_add_f16 v98, v98, v66
    v_pk_add_f16 v99, v99, v67
    ds_write_b128 v36, v[96:99] offset:11216
    v_pk_add_f16 v92, v121, v60
    v_pk_add_f16 v93, v93, v61
    v_pk_add_f16 v94, v94, v62
    v_pk_add_f16 v95, v95, v63
    ds_write_b128 v36, v[92:95] offset:11200
    s_setprio 0
    s_not_b64 s[48:49], vcc
    s_cbranch_scc0 B_nolose2
    s_and_b64 s[54:55], s[48:49], s[46:47]
    s_cbranch_scc0 B_stash2
    s_call_b64 s[50:51], B_drain
B_stash2:
    s_mov_b64 exec, s[48:49]
    s_or_b64 s[46:47], s[46:47], s[48:49]
    v_mov_b64 v[104:105], v[60:61]
    v_mov_b64 v[106:107], v[62:63]
    v_mov_b64 v[108:109], v[64:65]
    v_mov_b64 v[110:111], v[66:67]
    v_mov_b32 v120, v36
B_nolose2:
    s_mov_b64 exec, -1
    s_cmp_lg_u32 s44, 0x60
    s_cbranch_scc1 B_loop_exit
    s_waitcnt lgkmcnt(2)
    v_pk_mul_f16 v100, v56, v123 op_sel:[0,0] op_sel_hi:[1,0]
    v_pk_mul_f16 v101, v57, v123 op_sel:[0,0] op_sel_hi:[1,0]
    v_pk_mul_f16 v102, v58, v123 op_sel:[0,0] op_sel_hi:[1,0]
    v_pk_mul_f16 v103, v59, v123 op_sel:[0,0] op_sel_hi:[1,0]
    v_pk_mul_f16 v92, v56, v124 op_sel:[0,0] op_sel_hi:[1,0]
    v_pk_mul_f16 v93, v56, v123 op_sel:[0,1] op_sel_hi:[1,1]
    v_pk_mul_f16 v94, v57, v124 op_sel:[0,0] op_sel_hi:[1,0]
    v_pk_mul_f16 v95, v57, v123 op_sel:[0,1] op_sel_hi:[1,1]
    v_mfma_f32_32x32x16_f16 v[76:91], v[2:5], v[100:103], 0
    v_pk_mul_f16 v96, v58, v124 op_sel:[0,0] op_sel_hi:[1,0]
    v_pk_mul_f16 v97, v58, v123 op_sel:[0,1] op_sel_hi:[1,1]
    v_pk_mul_f16 v98, v59, v124 op_sel:[0,0] op_sel_hi:[1,0]
    v_pk_mul_f16 v99, v59, v123 op_sel:[0,1] op_sel_hi:[1,1]
    v_permlane32_swap_b32 v92, v93
    v_permlane32_swap_b32 v94, v95
    v_permlane32_swap_b32 v96, v97
    v_permlane32_swap_b32 v98, v99
    s_nop 1
    v_smfmac_f32_32x32x32_f16 v[76:91], v[6:9], v[92:99], v119
    s_waitcnt vmcnt(0)
    s_mov_b64 vcc, s[100:101]
    v_cndmask_b32_dpp v92, v52, v48, vcc quad_perm:[1,0,3,2] row_mask:0xf bank_mask:0xf
    v_cndmask_b32_dpp v93, v53, v49, vcc quad_perm:[1,0,3,2] row_mask:0xf bank_mask:0xf
    v_cndmask_b32_dpp v94, v54, v50, vcc quad_perm:[1,0,3,2] row_mask:0xf bank_mask:0xf
    v_cndmask_b32_dpp v95, v55, v51, vcc quad_perm:[1,0,3,2] row_mask:0xf bank_mask:0xf
    s_not_b64 vcc, vcc
    v_cndmask_b32_dpp v96, v48, v52, vcc quad_perm:[1,0,3,2] row_mask:0xf bank_mask:0xf
    v_cndmask_b32_dpp v97, v49, v53, vcc quad_perm:[1,0,3,2] row_mask:0xf bank_mask:0xf
    v_cndmask_b32_dpp v98, v50, v54, vcc quad_perm:[1,0,3,2] row_mask:0xf bank_mask:0xf
    v_cndmask_b32_dpp v99, v51, v55, vcc quad_perm:[1,0,3,2] row_mask:0xf bank_mask:0xf
    v_mfma_f32_32x32x16_bf16 v[60:75], v[14:17], v[92:95], 0
    s_nop 0
    v_mfma_f32_32x32x16_bf16 v[60:75], v[18:21], v[96:99], v[60:75]
    v_and_b32_dpp v22, v38, v1 quad_perm:[0,0,2,2] row_mask:0xf bank_mask:0xf
    buffer_load_dwordx4 v[48:51], v[22:23], s[8:11], 0 idxen offen
    v_and_b32_dpp v22, v38, v1 quad_perm:[1,1,3,3] row_mask:0xf bank_mask:0xf
    buffer_load_dwordx4 v[52:55], v[22:23], s[8:11], 0 idxen offen
    v_lshrrev_b32 v38, 20, v38
    v_mul_u32_u24 v38, 48, v38
    v_and_b32 v46, 0xff, v45
    v_lshlrev_b32 v46, 3, v46
    ds_read_b64 v[46:47], v46 offset:16
    v_mul_f32 v101, 0x7cc00000, v116
    v_mul_f32 v100, 0x7aa2f983, v116
    v_cvt_pk_bf16_f32 v101, 0, v101
    v_cos_f32 v100, v100
    v_mul_f32 v101, 0.15915494, v101
    v_cos_f32 v101, v101
    v_fma_mixlo_f16 v124, v100, v100, -0.5
    v_cvt_pk_f16_f32 v123, v100, v101
    v_pk_mul_f32 v[76:77], v[60:61], v[76:77]
    v_pk_mul_f32 v[78:79], v[62:63], v[78:79]
    v_pk_mul_f32 v[80:81], v[64:65], v[80:81]
    v_pk_mul_f32 v[82:83], v[66:67], v[82:83]
    v_pk_mul_f32 v[84:85], v[68:69], v[84:85]
    v_pk_mul_f32 v[86:87], v[70:71], v[86:87]
    v_pk_mul_f32 v[88:89], v[72:73], v[88:89]
    v_pk_mul_f32 v[90:91], v[74:75], v[90:91]
    s_setprio 2
    ds_wrxchg_rtn_b32 v121, v37, v122 offset:11200
    ds_read_b128 v[96:99], v37 offset:11216
    ds_read_b128 v[92:95], v37 offset:11200
    ds_read_b128 v[56:59], v38 offset:11232
    v_cvt_pk_f16_f32 v60, v76, v77
    v_cvt_pk_f16_f32 v61, v78, v79
    v_cvt_pk_f16_f32 v62, v80, v81
    v_cvt_pk_f16_f32 v63, v82, v83
    v_cvt_pk_f16_f32 v64, v84, v85
    v_cvt_pk_f16_f32 v65, v86, v87
    v_cvt_pk_f16_f32 v66, v88, v89
    v_cvt_pk_f16_f32 v67, v90, v91
    s_waitcnt lgkmcnt(1)
    v_cmp_ne_u32 vcc, v121, v122
    s_mov_b64 exec, vcc
    v_pk_add_f16 v96, v96, v64
    v_pk_add_f16 v97, v97, v65
    v_pk_add_f16 v98, v98, v66
    v_pk_add_f16 v99, v99, v67
    ds_write_b128 v37, v[96:99] offset:11216
    v_pk_add_f16 v92, v121, v60
    v_pk_add_f16 v93, v93, v61
    v_pk_add_f16 v94, v94, v62
    v_pk_add_f16 v95, v95, v63
    ds_write_b128 v37, v[92:95] offset:11200
    s_setprio 0
    s_not_b64 s[48:49], vcc
    s_cbranch_scc0 B_nolose3
    s_and_b64 s[54:55], s[48:49], s[46:47]
    s_cbranch_scc0 B_stash3
    s_call_b64 s[50:51], B_drain
B_stash3:
    s_mov_b64 exec, s[48:49]
    s_or_b64 s[46:47], s[46:47], s[48:49]
    v_mov_b64 v[104:105], v[60:61]
    v_mov_b64 v[106:107], v[62:63]
    v_mov_b64 v[108:109], v[64:65]
    v_mov_b64 v[110:111], v[66:67]
    v_mov_b32 v120, v37
B_nolose3:
    s_mov_b64 exec, -1
    s_waitcnt lgkmcnt(2)
    v_pk_mul_f16 v100, v56, v123 op_sel:[0,0] op_sel_hi:[1,0]
    v_pk_mul_f16 v101, v57, v123 op_sel:[0,0] op_sel_hi:[1,0]
    v_pk_mul_f16 v102, v58, v123 op_sel:[0,0] op_sel_hi:[1,0]
    v_pk_mul_f16 v103, v59, v123 op_sel:[0,0] op_sel_hi:[1,0]
    v_pk_mul_f16 v92, v56, v124 op_sel:[0,0] op_sel_hi:[1,0]
    v_pk_mul_f16 v93, v56, v123 op_sel:[0,1] op_sel_hi:[1,1]
    v_pk_mul_f16 v94, v57, v124 op_sel:[0,0] op_sel_hi:[1,0]
    v_pk_mul_f16 v95, v57, v123 op_sel:[0,1] op_sel_hi:[1,1]
    v_mfma_f32_32x32x16_f16 v[76:91], v[2:5], v[100:103], 0
    v_pk_mul_f16 v96, v58, v124 op_sel:[0,0] op_sel_hi:[1,0]
    v_pk_mul_f16 v97, v58, v123 op_sel:[0,1] op_sel_hi:[1,1]
    v_pk_mul_f16 v98, v59, v124 op_sel:[0,0] op_sel_hi:[1,0]
    v_pk_mul_f16 v99, v59, v123 op_sel:[0,1] op_sel_hi:[1,1]
    v_permlane32_swap_b32 v92, v93
    v_permlane32_swap_b32 v94, v95
    v_permlane32_swap_b32 v96, v97
    v_permlane32_swap_b32 v98, v99
    s_nop 1
    v_smfmac_f32_32x32x32_f16 v[76:91], v[6:9], v[92:99], v119
    s_waitcnt vmcnt(0)
    s_mov_b64 vcc, s[100:101]
    v_cndmask_b32_dpp v92, v52, v48, vcc quad_perm:[1,0,3,2] row_mask:0xf bank_mask:0xf
    v_cndmask_b32_dpp v93, v53, v49, vcc quad_perm:[1,0,3,2] row_mask:0xf bank_mask:0xf
    v_cndmask_b32_dpp v94, v54, v50, vcc quad_perm:[1,0,3,2] row_mask:0xf bank_mask:0xf
    v_cndmask_b32_dpp v95, v55, v51, vcc quad_perm:[1,0,3,2] row_mask:0xf bank_mask:0xf
    s_not_b64 vcc, vcc
    v_cndmask_b32_dpp v96, v48, v52, vcc quad_perm:[1,0,3,2] row_mask:0xf bank_mask:0xf
    v_cndmask_b32_dpp v97, v49, v53, vcc quad_perm:[1,0,3,2] row_mask:0xf bank_mask:0xf
    v_cndmask_b32_dpp v98, v50, v54, vcc quad_perm:[1,0,3,2] row_mask:0xf bank_mask:0xf
    v_cndmask_b32_dpp v99, v51, v55, vcc quad_perm:[1,0,3,2] row_mask:0xf bank_mask:0xf
    v_mfma_f32_32x32x16_bf16 v[60:75], v[14:17], v[92:95], 0
    s_nop 0
    v_mfma_f32_32x32x16_bf16 v[60:75], v[18:21], v[96:99], v[60:75]
    v_bfe_u32 v45, v45, 8, 22
    v_and_b32 v41, 0xfff, v46
    v_add3_u32 v41, v41, v45, s35
    v_bfe_u32 v27, v46, 12, 15
    v_lshrrev_b32 v26, 6, v41
    v_add_u32 v26, v26, v27
    v_lshl_add_u32 v41, v26, 6, v41
    v_add_u32 v45, s35, v45
    s_nop 0
    v_mov_b32_dpp v24, v41 quad_perm:[0,0,0,0] row_mask:0xf bank_mask:0xf
    buffer_load_dwordx4 v[26:29], v[24:25], s[12:15], 0 idxen offen nt
    v_mov_b32_dpp v24, v41 quad_perm:[1,1,1,1] row_mask:0xf bank_mask:0xf
    buffer_load_dwordx4 v[30:33], v[24:25], s[12:15], 0 idxen offen nt
    v_and_b32_dpp v22, v39, v1 quad_perm:[0,0,2,2] row_mask:0xf bank_mask:0xf
    buffer_load_dwordx4 v[48:51], v[22:23], s[8:11], 0 idxen offen
    v_and_b32_dpp v22, v39, v1 quad_perm:[1,1,3,3] row_mask:0xf bank_mask:0xf
    buffer_load_dwordx4 v[52:55], v[22:23], s[8:11], 0 idxen offen
    v_lshrrev_b32 v39, 20, v39
    v_mul_u32_u24 v39, 48, v39
    v_mul_f32 v101, 0x7cc00000, v117
    v_mul_f32 v100, 0x7aa2f983, v117
    v_cvt_pk_bf16_f32 v101, 0, v101
    v_cos_f32 v100, v100
    v_mul_f32 v101, 0.15915494, v101
    v_cos_f32 v101, v101
    v_fma_mixlo_f16 v124, v100, v100, -0.5
    v_cvt_pk_f16_f32 v123, v100, v101
    v_pk_mul_f32 v[76:77], v[60:61], v[76:77]
    v_pk_mul_f32 v[78:79], v[62:63], v[78:79]
    v_pk_mul_f32 v[80:81], v[64:65], v[80:81]
    v_pk_mul_f32 v[82:83], v[66:67], v[82:83]
    v_pk_mul_f32 v[84:85], v[68:69], v[84:85]
    v_pk_mul_f32 v[86:87], v[70:71], v[86:87]
    v_pk_mul_f32 v[88:89], v[72:73], v[88:89]
    v_pk_mul_f32 v[90:91], v[74:75], v[90:91]
    s_setprio 2
    ds_wrxchg_rtn_b32 v121, v38, v122 offset:11200
    ds_read_b128 v[96:99], v38 offset:11216
    ds_read_b128 v[92:95], v38 offset:11200
    ds_read_b128 v[56:59], v39 offset:11232
    v_cvt_pk_f16_f32 v60, v76, v77
    v_cvt_pk_f16_f32 v61, v78, v79
    v_cvt_pk_f16_f32 v62, v80, v81
    v_cvt_pk_f16_f32 v63, v82, v83
    v_cvt_pk_f16_f32 v64, v84, v85
    v_cvt_pk_f16_f32 v65, v86, v87
    v_cvt_pk_f16_f32 v66, v88, v89
    v_cvt_pk_f16_f32 v67, v90, v91
    s_waitcnt lgkmcnt(1)
    v_cmp_ne_u32 vcc, v121, v122
    s_mov_b64 exec, vcc
    v_pk_add_f16 v96, v96, v64
    v_pk_add_f16 v97, v97, v65
    v_pk_add_f16 v98, v98, v66
    v_pk_add_f16 v99, v99, v67
    ds_write_b128 v38, v[96:99] offset:11216
    v_pk_add_f16 v92, v121, v60
    v_pk_add_f16 v93, v93, v61
    v_pk_add_f16 v94, v94, v62
    v_pk_add_f16 v95, v95, v63
    ds_write_b128 v38, v[92:95] offset:11200
    s_setprio 0
    s_not_b64 s[48:49], vcc
    s_cbranch_scc0 B_nolose4
    s_and_b64 s[54:55], s[48:49], s[46:47]
    s_cbranch_scc0 B_stash4
    s_call_b64 s[50:51], B_drain
B_stash4:
    s_mov_b64 exec, s[48:49]
    s_or_b64 s[46:47], s[46:47], s[48:49]
    v_mov_b64 v[104:105], v[60:61]
    v_mov_b64 v[106:107], v[62:63]
    v_mov_b64 v[108:109], v[64:65]
    v_mov_b64 v[110:111], v[66:67]
    v_mov_b32 v120, v38
B_nolose4:
    s_mov_b64 exec, -1
    v_lshrrev_b32 v44, 16, v47
    v_and_b32 v47, 0xffff, v47
    v_lshrrev_b32 v46, 27, v46
    v_sub_u32 v44, v45, v44
    v_mad_i32_i24 v47, v45, s6, v47
    v_ashrrev_i32 v44, 31, v44
    v_add_u32 v46, v46, v47
    v_med3_i32 v47, v47, 0, 24
    v_med3_i32 v46, v46, 0, 24
    v_sub_u32 v46, v46, v47
    v_bfm_b32 v46, v46, v47
    v_and_b32 v45, 3, v40
    v_bfi_b32 v46, v44, v46, -1
    v_ashrrev_i32 v44, v45, v46
    s_waitcnt lgkmcnt(2)
    v_pk_mul_f16 v100, v56, v123 op_sel:[0,0] op_sel_hi:[1,0]
    v_pk_mul_f16 v101, v57, v123 op_sel:[0,0] op_sel_hi:[1,0]
    v_pk_mul_f16 v102, v58, v123 op_sel:[0,0] op_sel_hi:[1,0]
    v_pk_mul_f16 v103, v59, v123 op_sel:[0,0] op_sel_hi:[1,0]
    v_pk_mul_f16 v92, v56, v124 op_sel:[0,0] op_sel_hi:[1,0]
    v_pk_mul_f16 v93, v56, v123 op_sel:[0,1] op_sel_hi:[1,1]
    v_pk_mul_f16 v94, v57, v124 op_sel:[0,0] op_sel_hi:[1,0]
    v_pk_mul_f16 v95, v57, v123 op_sel:[0,1] op_sel_hi:[1,1]
    v_mfma_f32_32x32x16_f16 v[76:91], v[2:5], v[100:103], 0
    v_pk_mul_f16 v96, v58, v124 op_sel:[0,0] op_sel_hi:[1,0]
    v_pk_mul_f16 v97, v58, v123 op_sel:[0,1] op_sel_hi:[1,1]
    v_pk_mul_f16 v98, v59, v124 op_sel:[0,0] op_sel_hi:[1,0]
    v_pk_mul_f16 v99, v59, v123 op_sel:[0,1] op_sel_hi:[1,1]
    v_permlane32_swap_b32 v92, v93
    v_permlane32_swap_b32 v94, v95
    v_permlane32_swap_b32 v96, v97
    v_permlane32_swap_b32 v98, v99
    s_nop 1
    v_smfmac_f32_32x32x32_f16 v[76:91], v[6:9], v[92:99], v119
    s_waitcnt vmcnt(0)
    s_mov_b64 vcc, s[100:101]
    v_cndmask_b32_dpp v92, v52, v48, vcc quad_perm:[1,0,3,2] row_mask:0xf bank_mask:0xf
    v_cndmask_b32_dpp v93, v53, v49, vcc quad_perm:[1,0,3,2] row_mask:0xf bank_mask:0xf
    v_cndmask_b32_dpp v94, v54, v50, vcc quad_perm:[1,0,3,2] row_mask:0xf bank_mask:0xf
    v_cndmask_b32_dpp v95, v55, v51, vcc quad_perm:[1,0,3,2] row_mask:0xf bank_mask:0xf
    v_cndmask_b32_dpp v34, v30, v26, vcc quad_perm:[1,0,3,2] row_mask:0xf bank_mask:0xf
    v_cndmask_b32_dpp v35, v31, v27, vcc quad_perm:[1,0,3,2] row_mask:0xf bank_mask:0xf
    v_cndmask_b32_dpp v36, v32, v28, vcc quad_perm:[1,0,3,2] row_mask:0xf bank_mask:0xf
    v_cndmask_b32_dpp v43, v33, v29, vcc quad_perm:[1,0,3,2] row_mask:0xf bank_mask:0xf
    s_not_b64 vcc, vcc
    v_cndmask_b32_dpp v96, v48, v52, vcc quad_perm:[1,0,3,2] row_mask:0xf bank_mask:0xf
    v_cndmask_b32_dpp v97, v49, v53, vcc quad_perm:[1,0,3,2] row_mask:0xf bank_mask:0xf
    v_cndmask_b32_dpp v98, v50, v54, vcc quad_perm:[1,0,3,2] row_mask:0xf bank_mask:0xf
    v_cndmask_b32_dpp v99, v51, v55, vcc quad_perm:[1,0,3,2] row_mask:0xf bank_mask:0xf
    v_cndmask_b32_dpp v37, v26, v30, vcc quad_perm:[1,0,3,2] row_mask:0xf bank_mask:0xf
    v_cndmask_b32_dpp v38, v27, v31, vcc quad_perm:[1,0,3,2] row_mask:0xf bank_mask:0xf
    v_cndmask_b32_dpp v42, v28, v32, vcc quad_perm:[1,0,3,2] row_mask:0xf bank_mask:0xf
    v_cndmask_b32_dpp v118, v29, v33, vcc quad_perm:[1,0,3,2] row_mask:0xf bank_mask:0xf
    s_cmp_ge_u32 s34, s42
    s_cbranch_scc1 B_half
B_half_done:
    v_bfe_i32 v121, v44, 0, 1
    v_or_b32 v34, v121, v34
    v_mfma_f32_32x32x16_bf16 v[60:75], v[14:17], v[92:95], 0
    s_nop 0
    v_mfma_f32_32x32x16_bf16 v[60:75], v[18:21], v[96:99], v[60:75]
    v_and_b32_dpp v22, v34, v1 quad_perm:[0,0,2,2] row_mask:0xf bank_mask:0xf
    buffer_load_dwordx4 v[48:51], v[22:23], s[8:11], 0 idxen offen
    v_and_b32_dpp v22, v34, v1 quad_perm:[1,1,3,3] row_mask:0xf bank_mask:0xf
    buffer_load_dwordx4 v[52:55], v[22:23], s[8:11], 0 idxen offen
    v_lshrrev_b32 v34, 20, v34
    v_mul_u32_u24 v34, 48, v34
    v_lshrrev_b32 v112, 4, v43
    v_lshlrev_b32 v113, 6, v43
    v_lshlrev_b32 v114, 16, v43
    v_lshrrev_b32 v115, 4, v118
    v_lshlrev_b32 v116, 6, v118
    v_lshlrev_b32 v117, 16, v118
    v_lshlrev_b32 v100, 4, v44
    v_bitop3_b32 v100, v43, v118, v100 bitop3:0x54
    v_cmp_gt_i32 vcc, 0, v100
    v_and_b32 v112, 0x3ff0000, v112
    v_and_b32 v113, 0x3ff0000, v113
    v_and_b32 v114, 0x3ff0000, v114
    v_and_b32 v115, 0x3ff0000, v115
    v_and_b32 v116, 0x3ff0000, v116
    v_and_b32 v117, 0x3ff0000, v117
    s_cbranch_vccz B_ang1
    s_call_b64 s[50:51], B_wide
B_ang1:
    v_mul_f32 v101, 0x7cc00000, v112
    v_mul_f32 v100, 0x7aa2f983, v112
    v_cvt_pk_bf16_f32 v101, 0, v101
    v_cos_f32 v100, v100
    v_mul_f32 v101, 0.15915494, v101
    v_cos_f32 v101, v101
    v_fma_mixlo_f16 v124, v100, v100, -0.5
    v_cvt_pk_f16_f32 v123, v100, v101
    v_pk_mul_f32 v[76:77], v[60:61], v[76:77]
    v_pk_mul_f32 v[78:79], v[62:63], v[78:79]
    v_pk_mul_f32 v[80:81], v[64:65], v[80:81]
    v_pk_mul_f32 v[82:83], v[66:67], v[82:83]
    v_pk_mul_f32 v[84:85], v[68:69], v[84:85]
    v_pk_mul_f32 v[86:87], v[70:71], v[86:87]
    v_pk_mul_f32 v[88:89], v[72:73], v[88:89]
    v_pk_mul_f32 v[90:91], v[74:75], v[90:91]
    s_setprio 2
    ds_wrxchg_rtn_b32 v121, v39, v122 offset:11200
    ds_read_b128 v[96:99], v39 offset:11216
    ds_read_b128 v[92:95], v39 offset:11200
    ds_read_b128 v[56:59], v34 offset:11232
    v_cvt_pk_f16_f32 v60, v76, v77
    v_cvt_pk_f16_f32 v61, v78, v79
    v_cvt_pk_f16_f32 v62, v80, v81
    v_cvt_pk_f16_f32 v63, v82, v83
    v_cvt_pk_f16_f32 v64, v84, v85
    v_cvt_pk_f16_f32 v65, v86, v87
    v_cvt_pk_f16_f32 v66, v88, v89
    v_cvt_pk_f16_f32 v67, v90, v91
    s_waitcnt lgkmcnt(1)
    v_cmp_ne_u32 vcc, v121, v122
    s_mov_b64 exec, vcc
    v_pk_add_f16 v96, v96, v64
    v_pk_add_f16 v97, v97, v65
    v_pk_add_f16 v98, v98, v66
    v_pk_add_f16 v99, v99, v67
    ds_write_b128 v39, v[96:99] offset:11216
    v_pk_add_f16 v92, v121, v60
    v_pk_add_f16 v93, v93, v61
    v_pk_add_f16 v94, v94, v62
    v_pk_add_f16 v95, v95, v63
    ds_write_b128 v39, v[92:95] offset:11200
    s_setprio 0
    s_not_b64 s[48:49], vcc
    s_cbranch_scc0 B_nolose5
    s_and_b64 s[54:55], s[48:49], s[46:47]
    s_cbranch_scc0 B_stash5
    s_call_b64 s[50:51], B_drain
B_stash5:
    s_mov_b64 exec, s[48:49]
    s_or_b64 s[46:47], s[46:47], s[48:49]
    v_mov_b64 v[104:105], v[60:61]
    v_mov_b64 v[106:107], v[62:63]
    v_mov_b64 v[108:109], v[64:65]
    v_mov_b64 v[110:111], v[66:67]
    v_mov_b32 v120, v39
B_nolose5:
    s_mov_b64 exec, -1
    s_cmp_ge_u32 s34, s43
    s_cbranch_scc1 B_loop_exit
    v_bfe_i32 v121, v44, 4, 1
    v_or_b32 v35, v121, v35
    v_bfe_i32 v121, v44, 8, 1
    v_or_b32 v36, v121, v36
    v_bfe_i32 v121, v44, 12, 1
    v_or_b32 v37, v121, v37
    v_bfe_i32 v121, v44, 16, 1
    v_or_b32 v38, v121, v38
    s_waitcnt lgkmcnt(2)
    v_pk_mul_f16 v100, v56, v123 op_sel:[0,0] op_sel_hi:[1,0]
    v_pk_mul_f16 v101, v57, v123 op_sel:[0,0] op_sel_hi:[1,0]
    v_pk_mul_f16 v102, v58, v123 op_sel:[0,0] op_sel_hi:[1,0]
    v_pk_mul_f16 v103, v59, v123 op_sel:[0,0] op_sel_hi:[1,0]
    v_pk_mul_f16 v92, v56, v124 op_sel:[0,0] op_sel_hi:[1,0]
    v_pk_mul_f16 v93, v56, v123 op_sel:[0,1] op_sel_hi:[1,1]
    v_pk_mul_f16 v94, v57, v124 op_sel:[0,0] op_sel_hi:[1,0]
    v_pk_mul_f16 v95, v57, v123 op_sel:[0,1] op_sel_hi:[1,1]
    v_mfma_f32_32x32x16_f16 v[76:91], v[2:5], v[100:103], 0
    v_pk_mul_f16 v96, v58, v124 op_sel:[0,0] op_sel_hi:[1,0]
    v_pk_mul_f16 v97, v58, v123 op_sel:[0,1] op_sel_hi:[1,1]
    v_pk_mul_f16 v98, v59, v124 op_sel:[0,0] op_sel_hi:[1,0]
    v_pk_mul_f16 v99, v59, v123 op_sel:[0,1] op_sel_hi:[1,1]
    v_permlane32_swap_b32 v92, v93
    v_permlane32_swap_b32 v94, v95
    v_permlane32_swap_b32 v96, v97
    v_permlane32_swap_b32 v98, v99
    s_nop 1
    v_smfmac_f32_32x32x32_f16 v[76:91], v[6:9], v[92:99], v119
    s_branch B_loop
B_loop_exit:
    s_waitcnt lgkmcnt(2)
B_loop_done:
    s_add_u32 s36, s36, 1
    s_mov_b64 s[48:49], -1
    s_cmp_lt_u32 s36, s37
    s_cbranch_scc1 B_again
    s_cmp_lg_u32 s67, 0
    s_cbranch_scc1 B_masks
    s_mov_b64 s[86:87], -1
    s_mov_b64 s[88:89], -1
    s_mov_b64 s[90:91], -1
    s_mov_b64 s[92:93], -1
B_masks:
    s_lshl_b32 s40, s4, 5
    s_lshl_b32 s41, s5, 5
    s_add_u32 s96, s56, s40
    s_addc_u32 s97, s57, 0
    s_and_b32 s97, s97, 0xffff
    s_mov_b32 s98, s41
    s_mov_b32 s99, 0x20000
    v_and_b32 v127, 0x3df, v0
    v_bfe_u32 v1, v0, 5, 1
    v_lshlrev_b32 v1, 4, v1
    v_lshl_add_u32 v1, v127, 5, v1
    s_mov_b32 s39, 0
    buffer_load_dwordx4 v[26:29], v1, s[96:99], s39 offen
    buffer_load_dwordx4 v[30:33], v1, s[96:99], s39 offen offset:1024
    s_mov_b32 s39, 32768
    buffer_load_dwordx4 v[34:37], v1, s[96:99], s39 offen
    buffer_load_dwordx4 v[38:41], v1, s[96:99], s39 offen offset:1024
    s_mov_b32 s39, 65536
    buffer_load_dwordx4 v[42:45], v1, s[96:99], s39 offen
    buffer_load_dwordx4 v[46:49], v1, s[96:99], s39 offen offset:1024
    s_mov_b32 s39, 98304
    buffer_load_dwordx4 v[50:53], v1, s[96:99], s39 offen
    buffer_load_dwordx4 v[54:57], v1, s[96:99], s39 offen offset:1024
    v_mov_b32 v126, 0
    v_bfe_u32 v100, v0, 5, 1
    v_bfe_u32 v101, v0, 4, 1
    v_xor_b32 v100, v100, v101
    v_lshlrev_b32 v100, 18, v100
    v_and_b32 v101, 3, v0
    v_lshl_or_b32 v100, v101, 4, v100
    v_bfe_u32 v101, v0, 3, 1
    v_lshl_or_b32 v100, v101, 6, v100
    v_bfe_u32 v101, v0, 2, 1
    v_lshl_or_b32 v100, v101, 7, v100
    ds_read_b128 v[14:17], v100 offset:9104
    ds_read_b128 v[18:21], v100 offset:9360
    ds_read_b128 v[22:25], v100 offset:9616
    ds_read_b128 v[112:115], v126 offset:9872
    v_mul_u32_u24 v127, 48, v0
    s_cmp_eq_u64 s[46:47], 0
    s_cbranch_scc1 B_nopend
    s_call_b64 s[50:51], B_drain
    s_mov_b64 exec, -1
B_nopend:
    s_waitcnt lgkmcnt(0)
    s_barrier
    ds_read_b128 v[92:95], v127 offset:11200
    ds_read_b128 v[96:99], v127 offset:11216
    ds_read_b128 v[100:103], v127 offset:11232
    s_mul_i32 s35, s67, 12
    s_sub_i32 s35, s35, 674
    s_mov_b64 s[48:49], 0
    v_mov_b32 v121, 0x207
    v_add3_u32 v120, v112, v113, s35
    v_add3_u32 v120, v114, v115, v120
    v_ldexp_f32 v120, 1.0, v120
    s_add_u32 s20, s62, s40
    s_addc_u32 s21, s63, 0
    s_and_b32 s21, s21, 0xffff
    s_mov_b32 s22, s41
    s_mov_b32 s23, 0x20000
    v_add_u32 v127, 49152, v127
    ds_read_b128 v[2:5], v127 offset:11200
    ds_read_b128 v[6:9], v127 offset:11216
    ds_read_b128 v[10:13], v127 offset:11232
    s_waitcnt lgkmcnt(3) vmcnt(0)
    v_mfma_f32_32x32x16_f16 v[76:91], v[22:25], v[100:103], 0
    v_mfma_f32_32x32x16_f16 v[60:75], v[14:17], v[92:95], 0
    v_mfma_f32_32x32x16_f16 v[60:75], v[18:21], v[96:99], v[60:75]
    v_lshlrev_b32 v104, 16, v26
    v_and_b32 v105, 0xffff0000, v26
    v_lshlrev_b32 v106, 16, v27
    v_and_b32 v107, 0xffff0000, v27
    v_lshlrev_b32 v108, 16, v28
    v_and_b32 v109, 0xffff0000, v28
    v_lshlrev_b32 v110, 16, v29
    v_and_b32 v111, 0xffff0000, v29
    v_lshlrev_b32 v112, 16, v30
    v_and_b32 v113, 0xffff0000, v30
    v_lshlrev_b32 v114, 16, v31
    v_and_b32 v115, 0xffff0000, v31
    v_lshlrev_b32 v116, 16, v32
    v_and_b32 v117, 0xffff0000, v32
    v_lshlrev_b32 v118, 16, v33
    v_and_b32 v119, 0xffff0000, v33
    v_pk_mul_f32 v[76:77], v[76:77], v[120:121] op_sel_hi:[1,0]
    v_pk_mul_f32 v[78:79], v[78:79], v[120:121] op_sel_hi:[1,0]
    v_pk_mul_f32 v[80:81], v[80:81], v[120:121] op_sel_hi:[1,0]
    v_pk_mul_f32 v[82:83], v[82:83], v[120:121] op_sel_hi:[1,0]
    v_pk_mul_f32 v[84:85], v[84:85], v[120:121] op_sel_hi:[1,0]
    v_pk_mul_f32 v[86:87], v[86:87], v[120:121] op_sel_hi:[1,0]
    v_pk_mul_f32 v[88:89], v[88:89], v[120:121] op_sel_hi:[1,0]
    v_pk_mul_f32 v[90:91], v[90:91], v[120:121] op_sel_hi:[1,0]
    v_cmp_class_f32 vcc, v60, v121
    v_pk_fma_f32 v[104:105], v[60:61], v[76:77], v[104:105]
    v_pk_fma_f32 v[106:107], v[62:63], v[78:79], v[106:107]
    v_pk_fma_f32 v[108:109], v[64:65], v[80:81], v[108:109]
    v_pk_fma_f32 v[110:111], v[66:67], v[82:83], v[110:111]
    v_pk_fma_f32 v[112:113], v[68:69], v[84:85], v[112:113]
    v_pk_fma_f32 v[114:115], v[70:71], v[86:87], v[114:115]
    v_pk_fma_f32 v[116:117], v[72:73], v[88:89], v[116:117]
    v_pk_fma_f32 v[118:119], v[74:75], v[90:91], v[118:119]
    v_cvt_pk_bf16_f32 v26, v104, v105
    v_cvt_pk_bf16_f32 v27, v106, v107
    v_cvt_pk_bf16_f32 v28, v108, v109
    v_cvt_pk_bf16_f32 v29, v110, v111
    v_cvt_pk_bf16_f32 v30, v112, v113
    v_cvt_pk_bf16_f32 v31, v114, v115
    v_cvt_pk_bf16_f32 v32, v116, v117
    v_cvt_pk_bf16_f32 v33, v118, v119
    s_mov_b32 s39, 0
    s_mov_b64 exec, s[86:87]
    s_cbranch_execz B_nostore0
    buffer_store_dwordx4 v[26:29], v1, s[20:23], s39 offen nt
    buffer_store_dwordx4 v[30:33], v1, s[20:23], s39 offen offset:1024 nt
B_nostore0:
    s_mov_b64 exec, -1
    s_and_b64 s[86:87], s[86:87], vcc
    s_or_b64 s[48:49], s[48:49], s[86:87]
    v_add_u32 v127, 49152, v127
    ds_read_b128 v[92:95], v127 offset:11200
    ds_read_b128 v[96:99], v127 offset:11216
    ds_read_b128 v[100:103], v127 offset:11232
    s_waitcnt lgkmcnt(3)
    v_mfma_f32_32x32x16_f16 v[76:91], v[22:25], v[10:13], 0
    v_mfma_f32_32x32x16_f16 v[60:75], v[14:17], v[2:5], 0
    v_mfma_f32_32x32x16_f16 v[60:75], v[18:21], v[6:9], v[60:75]
    v_lshlrev_b32 v104, 16, v34
    v_and_b32 v105, 0xffff0000, v34
    v_lshlrev_b32 v106, 16, v35
    v_and_b32 v107, 0xffff0000, v35
    v_lshlrev_b32 v108, 16, v36
    v_and_b32 v109, 0xffff0000, v36
    v_lshlrev_b32 v110, 16, v37
    v_and_b32 v111, 0xffff0000, v37
    v_lshlrev_b32 v112, 16, v38
    v_and_b32 v113, 0xffff0000, v38
    v_lshlrev_b32 v114, 16, v39
    v_and_b32 v115, 0xffff0000, v39
    v_lshlrev_b32 v116, 16, v40
    v_and_b32 v117, 0xffff0000, v40
    v_lshlrev_b32 v118, 16, v41
    v_and_b32 v119, 0xffff0000, v41
    v_pk_mul_f32 v[76:77], v[76:77], v[120:121] op_sel_hi:[1,0]
    v_pk_mul_f32 v[78:79], v[78:79], v[120:121] op_sel_hi:[1,0]
    v_pk_mul_f32 v[80:81], v[80:81], v[120:121] op_sel_hi:[1,0]
    v_pk_mul_f32 v[82:83], v[82:83], v[120:121] op_sel_hi:[1,0]
    v_pk_mul_f32 v[84:85], v[84:85], v[120:121] op_sel_hi:[1,0]
    v_pk_mul_f32 v[86:87], v[86:87], v[120:121] op_sel_hi:[1,0]
    v_pk_mul_f32 v[88:89], v[88:89], v[120:121] op_sel_hi:[1,0]
    v_pk_mul_f32 v[90:91], v[90:91], v[120:121] op_sel_hi:[1,0]
    v_cmp_class_f32 vcc, v60, v121
    v_pk_fma_f32 v[104:105], v[60:61], v[76:77], v[104:105]
    v_pk_fma_f32 v[106:107], v[62:63], v[78:79], v[106:107]
    v_pk_fma_f32 v[108:109], v[64:65], v[80:81], v[108:109]
    v_pk_fma_f32 v[110:111], v[66:67], v[82:83], v[110:111]
    v_pk_fma_f32 v[112:113], v[68:69], v[84:85], v[112:113]
    v_pk_fma_f32 v[114:115], v[70:71], v[86:87], v[114:115]
    v_pk_fma_f32 v[116:117], v[72:73], v[88:89], v[116:117]
    v_pk_fma_f32 v[118:119], v[74:75], v[90:91], v[118:119]
    v_cvt_pk_bf16_f32 v34, v104, v105
    v_cvt_pk_bf16_f32 v35, v106, v107
    v_cvt_pk_bf16_f32 v36, v108, v109
    v_cvt_pk_bf16_f32 v37, v110, v111
    v_cvt_pk_bf16_f32 v38, v112, v113
    v_cvt_pk_bf16_f32 v39, v114, v115
    v_cvt_pk_bf16_f32 v40, v116, v117
    v_cvt_pk_bf16_f32 v41, v118, v119
    s_mov_b32 s39, 32768
    s_mov_b64 exec, s[88:89]
    s_cbranch_execz B_nostore1
    buffer_store_dwordx4 v[34:37], v1, s[20:23], s39 offen nt
    buffer_store_dwordx4 v[38:41], v1, s[20:23], s39 offen offset:1024 nt
B_nostore1:
    s_mov_b64 exec, -1
    s_and_b64 s[88:89], s[88:89], vcc
    s_or_b64 s[48:49], s[48:49], s[88:89]
    v_add_u32 v127, 49152, v127
    ds_read_b128 v[2:5], v127 offset:11200
    ds_read_b128 v[6:9], v127 offset:11216
    ds_read_b128 v[10:13], v127 offset:11232
    s_waitcnt lgkmcnt(3)
    v_mfma_f32_32x32x16_f16 v[76:91], v[22:25], v[100:103], 0
    v_mfma_f32_32x32x16_f16 v[60:75], v[14:17], v[92:95], 0
    v_mfma_f32_32x32x16_f16 v[60:75], v[18:21], v[96:99], v[60:75]
    v_lshlrev_b32 v104, 16, v42
    v_and_b32 v105, 0xffff0000, v42
    v_lshlrev_b32 v106, 16, v43
    v_and_b32 v107, 0xffff0000, v43
    v_lshlrev_b32 v108, 16, v44
    v_and_b32 v109, 0xffff0000, v44
    v_lshlrev_b32 v110, 16, v45
    v_and_b32 v111, 0xffff0000, v45
    v_lshlrev_b32 v112, 16, v46
    v_and_b32 v113, 0xffff0000, v46
    v_lshlrev_b32 v114, 16, v47
    v_and_b32 v115, 0xffff0000, v47
    v_lshlrev_b32 v116, 16, v48
    v_and_b32 v117, 0xffff0000, v48
    v_lshlrev_b32 v118, 16, v49
    v_and_b32 v119, 0xffff0000, v49
    v_pk_mul_f32 v[76:77], v[76:77], v[120:121] op_sel_hi:[1,0]
    v_pk_mul_f32 v[78:79], v[78:79], v[120:121] op_sel_hi:[1,0]
    v_pk_mul_f32 v[80:81], v[80:81], v[120:121] op_sel_hi:[1,0]
    v_pk_mul_f32 v[82:83], v[82:83], v[120:121] op_sel_hi:[1,0]
    v_pk_mul_f32 v[84:85], v[84:85], v[120:121] op_sel_hi:[1,0]
    v_pk_mul_f32 v[86:87], v[86:87], v[120:121] op_sel_hi:[1,0]
    v_pk_mul_f32 v[88:89], v[88:89], v[120:121] op_sel_hi:[1,0]
    v_pk_mul_f32 v[90:91], v[90:91], v[120:121] op_sel_hi:[1,0]
    v_cmp_class_f32 vcc, v60, v121
    v_pk_fma_f32 v[104:105], v[60:61], v[76:77], v[104:105]
    v_pk_fma_f32 v[106:107], v[62:63], v[78:79], v[106:107]
    v_pk_fma_f32 v[108:109], v[64:65], v[80:81], v[108:109]
    v_pk_fma_f32 v[110:111], v[66:67], v[82:83], v[110:111]
    v_pk_fma_f32 v[112:113], v[68:69], v[84:85], v[112:113]
    v_pk_fma_f32 v[114:115], v[70:71], v[86:87], v[114:115]
    v_pk_fma_f32 v[116:117], v[72:73], v[88:89], v[116:117]
    v_pk_fma_f32 v[118:119], v[74:75], v[90:91], v[118:119]
    v_cvt_pk_bf16_f32 v42, v104, v105
    v_cvt_pk_bf16_f32 v43, v106, v107
    v_cvt_pk_bf16_f32 v44, v108, v109
    v_cvt_pk_bf16_f32 v45, v110, v111
    v_cvt_pk_bf16_f32 v46, v112, v113
    v_cvt_pk_bf16_f32 v47, v114, v115
    v_cvt_pk_bf16_f32 v48, v116, v117
    v_cvt_pk_bf16_f32 v49, v118, v119
    s_mov_b32 s39, 65536
    s_mov_b64 exec, s[90:91]
    s_cbranch_execz B_nostore2
    buffer_store_dwordx4 v[42:45], v1, s[20:23], s39 offen nt
    buffer_store_dwordx4 v[46:49], v1, s[20:23], s39 offen offset:1024 nt
B_nostore2:
    s_mov_b64 exec, -1
    s_and_b64 s[90:91], s[90:91], vcc
    s_or_b64 s[48:49], s[48:49], s[90:91]
    s_cmp_ge_u32 s32, 2
    s_cbranch_scc1 B_epi_done
    s_waitcnt lgkmcnt(0)
    v_mfma_f32_32x32x16_f16 v[76:91], v[22:25], v[10:13], 0
    v_mfma_f32_32x32x16_f16 v[60:75], v[14:17], v[2:5], 0
    v_mfma_f32_32x32x16_f16 v[60:75], v[18:21], v[6:9], v[60:75]
    v_lshlrev_b32 v104, 16, v50
    v_and_b32 v105, 0xffff0000, v50
    v_lshlrev_b32 v106, 16, v51
    v_and_b32 v107, 0xffff0000, v51
    v_lshlrev_b32 v108, 16, v52
    v_and_b32 v109, 0xffff0000, v52
    v_lshlrev_b32 v110, 16, v53
    v_and_b32 v111, 0xffff0000, v53
    v_lshlrev_b32 v112, 16, v54
    v_and_b32 v113, 0xffff0000, v54
    v_lshlrev_b32 v114, 16, v55
    v_and_b32 v115, 0xffff0000, v55
    v_lshlrev_b32 v116, 16, v56
    v_and_b32 v117, 0xffff0000, v56
    v_lshlrev_b32 v118, 16, v57
    v_and_b32 v119, 0xffff0000, v57
    v_pk_mul_f32 v[76:77], v[76:77], v[120:121] op_sel_hi:[1,0]
    v_pk_mul_f32 v[78:79], v[78:79], v[120:121] op_sel_hi:[1,0]
    v_pk_mul_f32 v[80:81], v[80:81], v[120:121] op_sel_hi:[1,0]
    v_pk_mul_f32 v[82:83], v[82:83], v[120:121] op_sel_hi:[1,0]
    v_pk_mul_f32 v[84:85], v[84:85], v[120:121] op_sel_hi:[1,0]
    v_pk_mul_f32 v[86:87], v[86:87], v[120:121] op_sel_hi:[1,0]
    v_pk_mul_f32 v[88:89], v[88:89], v[120:121] op_sel_hi:[1,0]
    v_pk_mul_f32 v[90:91], v[90:91], v[120:121] op_sel_hi:[1,0]
    v_cmp_class_f32 vcc, v60, v121
    v_pk_fma_f32 v[104:105], v[60:61], v[76:77], v[104:105]
    v_pk_fma_f32 v[106:107], v[62:63], v[78:79], v[106:107]
    v_pk_fma_f32 v[108:109], v[64:65], v[80:81], v[108:109]
    v_pk_fma_f32 v[110:111], v[66:67], v[82:83], v[110:111]
    v_pk_fma_f32 v[112:113], v[68:69], v[84:85], v[112:113]
    v_pk_fma_f32 v[114:115], v[70:71], v[86:87], v[114:115]
    v_pk_fma_f32 v[116:117], v[72:73], v[88:89], v[116:117]
    v_pk_fma_f32 v[118:119], v[74:75], v[90:91], v[118:119]
    v_cvt_pk_bf16_f32 v50, v104, v105
    v_cvt_pk_bf16_f32 v51, v106, v107
    v_cvt_pk_bf16_f32 v52, v108, v109
    v_cvt_pk_bf16_f32 v53, v110, v111
    v_cvt_pk_bf16_f32 v54, v112, v113
    v_cvt_pk_bf16_f32 v55, v114, v115
    v_cvt_pk_bf16_f32 v56, v116, v117
    v_cvt_pk_bf16_f32 v57, v118, v119
    s_mov_b32 s39, 98304
    s_mov_b64 exec, s[92:93]
    s_cbranch_execz B_nostore3
    buffer_store_dwordx4 v[50:53], v1, s[20:23], s39 offen nt
    buffer_store_dwordx4 v[54:57], v1, s[20:23], s39 offen offset:1024 nt
B_nostore3:
    s_mov_b64 exec, -1
    s_and_b64 s[92:93], s[92:93], vcc
    s_or_b64 s[48:49], s[48:49], s[92:93]
B_epi_done:
    v_mov_b32 v126, 0
    s_cmp_eq_u64 s[48:49], 0
    s_cbranch_scc1 B_clean
    ds_write_b32 v126, v121 offset:4
B_clean:
    s_waitcnt lgkmcnt(0)
    s_barrier
    ds_read_b32 v126, v126 offset:4
    s_add_u32 s67, s67, 1
    s_waitcnt lgkmcnt(0)
    v_readfirstlane_b32 s39, v126
    s_cmp_gt_u32 s67, 24
    s_cselect_b32 s39, 0, s39
    s_cmp_lg_u32 s39, 0
    s_cbranch_scc1 B_redo
B_end:
    s_endpgm
B_again:
    s_cmp_eq_u64 s[46:47], 0
    s_cbranch_scc1 B_again1
    s_call_b64 s[50:51], B_drain
    s_mov_b64 exec, -1
B_again1:
    s_add_u32 s35, s35, 9
    s_movk_i32 s44, 0x60
    v_lshrrev_b32 v45, 2, v40
    s_cmp_ge_u32 s32, 12
    s_waitcnt vmcnt(0) lgkmcnt(0)
    s_barrier
    s_cbranch_scc1 B_list
    v_and_b32 v46, 0xff, v45
    v_lshlrev_b32 v46, 3, v46
    ds_read_b64 v[46:47], v46 offset:16
    s_waitcnt lgkmcnt(0)
    v_bfe_u32 v45, v45, 8, 22
    v_and_b32 v41, 0xfff, v46
    v_add3_u32 v41, v41, v45, s35
    v_bfe_u32 v27, v46, 12, 15
    v_lshrrev_b32 v26, 6, v41
    v_add_u32 v26, v26, v27
    v_lshl_add_u32 v41, v26, 6, v41
    v_add_u32 v45, s35, v45
    s_nop 0
    v_mov_b32_dpp v24, v41 quad_perm:[0,0,0,0] row_mask:0xf bank_mask:0xf
    buffer_load_dwordx4 v[26:29], v[24:25], s[12:15], 0 idxen offen nt
    v_mov_b32_dpp v24, v41 quad_perm:[1,1,1,1] row_mask:0xf bank_mask:0xf
    buffer_load_dwordx4 v[30:33], v[24:25], s[12:15], 0 idxen offen nt
    v_lshrrev_b32 v44, 16, v47
    v_and_b32 v47, 0xffff, v47
    v_lshrrev_b32 v46, 27, v46
    v_sub_u32 v44, v45, v44
    v_mad_i32_i24 v47, v45, s6, v47
    v_ashrrev_i32 v44, 31, v44
    v_add_u32 v46, v46, v47
    v_med3_i32 v47, v47, 0, 24
    v_med3_i32 v46, v46, 0, 24
    v_sub_u32 v46, v46, v47
    v_bfm_b32 v46, v46, v47
    v_and_b32 v45, 3, v40
    v_bfi_b32 v46, v44, v46, -1
    v_ashrrev_i32 v44, v45, v46
    s_waitcnt vmcnt(0)
    s_mov_b64 vcc, s[100:101]
    v_cndmask_b32_dpp v34, v30, v26, vcc quad_perm:[1,0,3,2] row_mask:0xf bank_mask:0xf
    v_cndmask_b32_dpp v35, v31, v27, vcc quad_perm:[1,0,3,2] row_mask:0xf bank_mask:0xf
    v_cndmask_b32_dpp v36, v32, v28, vcc quad_perm:[1,0,3,2] row_mask:0xf bank_mask:0xf
    v_cndmask_b32_dpp v43, v33, v29, vcc quad_perm:[1,0,3,2] row_mask:0xf bank_mask:0xf
    s_not_b64 vcc, vcc
    v_cndmask_b32_dpp v37, v26, v30, vcc quad_perm:[1,0,3,2] row_mask:0xf bank_mask:0xf
    v_cndmask_b32_dpp v38, v27, v31, vcc quad_perm:[1,0,3,2] row_mask:0xf bank_mask:0xf
    v_cndmask_b32_dpp v42, v28, v32, vcc quad_perm:[1,0,3,2] row_mask:0xf bank_mask:0xf
    v_cndmask_b32_dpp v118, v29, v33, vcc quad_perm:[1,0,3,2] row_mask:0xf bank_mask:0xf
    v_bfe_i32 v121, v44, 0, 1
    v_or_b32 v34, v121, v34
    v_bfe_i32 v121, v44, 4, 1
    v_or_b32 v35, v121, v35
    v_bfe_i32 v121, v44, 8, 1
    v_or_b32 v36, v121, v36
    v_bfe_i32 v121, v44, 12, 1
    v_or_b32 v37, v121, v37
    v_bfe_i32 v121, v44, 16, 1
    v_or_b32 v38, v121, v38
    v_and_b32_dpp v22, v34, v1 quad_perm:[0,0,2,2] row_mask:0xf bank_mask:0xf
    buffer_load_dwordx4 v[48:51], v[22:23], s[8:11], 0 idxen offen
    v_and_b32_dpp v22, v34, v1 quad_perm:[1,1,3,3] row_mask:0xf bank_mask:0xf
    buffer_load_dwordx4 v[52:55], v[22:23], s[8:11], 0 idxen offen
    v_lshrrev_b32 v34, 20, v34
    v_mul_u32_u24 v34, 48, v34
    v_lshrrev_b32 v112, 4, v43
    v_lshlrev_b32 v113, 6, v43
    v_lshlrev_b32 v114, 16, v43
    v_lshrrev_b32 v115, 4, v118
    v_lshlrev_b32 v116, 6, v118
    v_lshlrev_b32 v117, 16, v118
    v_lshlrev_b32 v100, 4, v44
    v_bitop3_b32 v100, v43, v118, v100 bitop3:0x54
    v_cmp_gt_i32 vcc, 0, v100
    v_and_b32 v112, 0x3ff0000, v112
    v_and_b32 v113, 0x3ff0000, v113
    v_and_b32 v114, 0x3ff0000, v114
    v_and_b32 v115, 0x3ff0000, v115
    v_and_b32 v116, 0x3ff0000, v116
    v_and_b32 v117, 0x3ff0000, v117
    s_cbranch_vccz B_ang2
    s_call_b64 s[50:51], B_wide
B_ang2:
    v_mul_f32 v101, 0x7cc00000, v112
    v_mul_f32 v100, 0x7aa2f983, v112
    v_cvt_pk_bf16_f32 v101, 0, v101
    v_cos_f32 v100, v100
    v_mul_f32 v101, 0.15915494, v101
    v_cos_f32 v101, v101
    v_fma_mixlo_f16 v124, v100, v100, -0.5
    v_cvt_pk_f16_f32 v123, v100, v101
    s_waitcnt vmcnt(0)
    s_mov_b64 vcc, s[100:101]
    v_cndmask_b32_dpp v92, v52, v48, vcc quad_perm:[1,0,3,2] row_mask:0xf bank_mask:0xf
    v_cndmask_b32_dpp v93, v53, v49, vcc quad_perm:[1,0,3,2] row_mask:0xf bank_mask:0xf
    v_cndmask_b32_dpp v94, v54, v50, vcc quad_perm:[1,0,3,2] row_mask:0xf bank_mask:0xf
    v_cndmask_b32_dpp v95, v55, v51, vcc quad_perm:[1,0,3,2] row_mask:0xf bank_mask:0xf
    s_not_b64 vcc, vcc
    v_cndmask_b32_dpp v96, v48, v52, vcc quad_perm:[1,0,3,2] row_mask:0xf bank_mask:0xf
    v_cndmask_b32_dpp v97, v49, v53, vcc quad_perm:[1,0,3,2] row_mask:0xf bank_mask:0xf
    v_cndmask_b32_dpp v98, v50, v54, vcc quad_perm:[1,0,3,2] row_mask:0xf bank_mask:0xf
    v_cndmask_b32_dpp v99, v51, v55, vcc quad_perm:[1,0,3,2] row_mask:0xf bank_mask:0xf
    v_mfma_f32_32x32x16_bf16 v[60:75], v[14:17], v[92:95], 0
    s_nop 0
    v_mfma_f32_32x32x16_bf16 v[60:75], v[18:21], v[96:99], v[60:75]
    v_and_b32_dpp v22, v35, v1 quad_perm:[0,0,2,2] row_mask:0xf bank_mask:0xf
    buffer_load_dwordx4 v[48:51], v[22:23], s[8:11], 0 idxen offen
    v_and_b32_dpp v22, v35, v1 quad_perm:[1,1,3,3] row_mask:0xf bank_mask:0xf
    buffer_load_dwordx4 v[52:55], v[22:23], s[8:11], 0 idxen offen
    v_lshrrev_b32 v35, 20, v35
    v_mul_u32_u24 v35, 48, v35
    s_branch B_join
B_hent:
    s_min_u32 s39, s34, s43
    s_add_u32 s39, s39, s42
    v_and_or_b32 v45, v0, 56, s39
    v_lshrrev_b32 v45, 1, v45
    s_branch B_hent_done
B_half:
    s_movk_i32 s44, 0x70
    s_mov_b64 exec, vcc
    v_mov_b32 v34, v37
    v_mov_b32 v35, v38
    v_mov_b32 v36, v42
    v_mov_b32 v43, v118
    v_ashrrev_i32 v44, 12, v44
    s_mov_b64 exec, -1
    v_mov_b32 v118, 0
    v_or_b32 v44, 0xfff000, v44
    v_bfrev_b32 v45, 2
    s_branch B_half_done
B_redo:
    s_waitcnt vmcnt(0)
    s_branch B_restart
B_rescale:
    s_mul_i32 s39, s67, -12
    v_lshlrev_b32 v92, 16, v14
    v_and_b32 v93, 0xffff0000, v14
    v_ldexp_f32 v92, v92, s39
    v_ldexp_f32 v93, v93, s39
    v_cvt_pk_bf16_f32 v14, v92, v93
    v_lshlrev_b32 v92, 16, v15
    v_and_b32 v93, 0xffff0000, v15
    v_ldexp_f32 v92, v92, s39
    v_ldexp_f32 v93, v93, s39
    v_cvt_pk_bf16_f32 v15, v92, v93
    v_lshlrev_b32 v92, 16, v16
    v_and_b32 v93, 0xffff0000, v16
    v_ldexp_f32 v92, v92, s39
    v_ldexp_f32 v93, v93, s39
    v_cvt_pk_bf16_f32 v16, v92, v93
    v_lshlrev_b32 v92, 16, v17
    v_and_b32 v93, 0xffff0000, v17
    v_ldexp_f32 v92, v92, s39
    v_ldexp_f32 v93, v93, s39
    v_cvt_pk_bf16_f32 v17, v92, v93
    v_lshlrev_b32 v92, 16, v18
    v_and_b32 v93, 0xffff0000, v18
    v_ldexp_f32 v92, v92, s39
    v_ldexp_f32 v93, v93, s39
    v_cvt_pk_bf16_f32 v18, v92, v93
    v_lshlrev_b32 v92, 16, v19
    v_and_b32 v93, 0xffff0000, v19
    v_ldexp_f32 v92, v92, s39
    v_ldexp_f32 v93, v93, s39
    v_cvt_pk_bf16_f32 v19, v92, v93
    v_lshlrev_b32 v92, 16, v20
    v_and_b32 v93, 0xffff0000, v20
    v_ldexp_f32 v92, v92, s39
    v_ldexp_f32 v93, v93, s39
    v_cvt_pk_bf16_f32 v20, v92, v93
    v_lshlrev_b32 v92, 16, v21
    v_and_b32 v93, 0xffff0000, v21
    v_ldexp_f32 v92, v92, s39
    v_ldexp_f32 v93, v93, s39
    v_cvt_pk_bf16_f32 v21, v92, v93
    s_branch B_rescaled
B_wide:
    v_xor_b32 v26, 64, v41
    v_and_b32 v27, s44, v25
    s_mov_b64 exec, vcc
    buffer_load_dwordx2 v[100:101], v[26:27], s[12:15], 0 idxen offen
    buffer_load_dwordx2 v[102:103], v[26:27], s[12:15], 0 idxen offen offset:16
    v_cmp_gt_i32 s[54:55], 0, v118
    v_cmp_gt_i32 vcc, 0, v43
    s_waitcnt vmcnt(0)
    s_mov_b64 exec, vcc
    v_lshlrev_b32 v112, 16, v100
    v_and_b32 v113, 0xffff0000, v100
    v_lshlrev_b32 v114, 16, v101
    s_mov_b64 exec, s[54:55]
    v_lshlrev_b32 v115, 16, v102
    v_and_b32 v116, 0xffff0000, v102
    v_lshlrev_b32 v117, 16, v103
    s_mov_b64 exec, -1
    v_bfe_i32 v100, v44, 0, 1
    v_bfi_b32 v112, v100, 0, v112
    v_bfe_i32 v100, v44, 4, 1
    v_bfi_b32 v113, v100, 0, v113
    v_bfe_i32 v100, v44, 8, 1
    v_bfi_b32 v114, v100, 0, v114
    v_bfe_i32 v100, v44, 12, 1
    v_bfi_b32 v115, v100, 0, v115
    v_bfe_i32 v100, v44, 16, 1
    v_bfi_b32 v116, v100, 0, v116
    v_bfe_i32 v100, v44, 20, 1
    v_bfi_b32 v117, v100, 0, v117
    s_setpc_b64 s[50:51]
B_drain:
    s_mov_b64 exec, s[46:47]
    ds_wrxchg_rtn_b32 v121, v120, v122 offset:11200
    ds_read_b128 v[96:99], v120 offset:11216
    ds_read_b128 v[92:95], v120 offset:11200
    s_waitcnt lgkmcnt(0)
    v_cmp_ne_u32 vcc, v121, v122
    s_mov_b64 exec, vcc
    s_andn2_b64 s[46:47], s[46:47], vcc
    v_pk_add_f16 v96, v96, v108
    v_pk_add_f16 v97, v97, v109
    v_pk_add_f16 v98, v98, v110
    v_pk_add_f16 v99, v99, v111
    ds_write_b128 v120, v[96:99] offset:11216
    v_pk_add_f16 v92, v121, v104
    v_pk_add_f16 v93, v93, v105
    v_pk_add_f16 v94, v94, v106
    v_pk_add_f16 v95, v95, v107
    ds_write_b128 v120, v[92:95] offset:11200
    s_and_b64 s[54:55], s[48:49], s[46:47]
    s_cbranch_scc1 B_merge
    s_setpc_b64 s[50:51]
B_merge:
    s_mov_b64 exec, s[54:55]
    v_readfirstlane_b32 s39, v120
    s_mov_b64 exec, s[46:47]
    s_nop 0
    v_cmp_eq_u32 s[54:55], s39, v120
    s_bcnt1_i32_b64 s39, s[54:55]
    s_cmp_lt_u32 s39, 3
    s_cbranch_scc1 B_drain
    s_mov_b64 exec, -1
    v_cndmask_b32 v92, 0, v104, s[54:55]
    v_cndmask_b32 v93, 0, v105, s[54:55]
    v_cndmask_b32 v94, 0, v106, s[54:55]
    v_cndmask_b32 v95, 0, v107, s[54:55]
    v_cndmask_b32 v96, 0, v108, s[54:55]
    v_cndmask_b32 v97, 0, v109, s[54:55]
    v_cndmask_b32 v98, 0, v110, s[54:55]
    v_cndmask_b32 v99, 0, v111, s[54:55]
    v_mov_b32_dpp v100, v92 row_shr:1 row_mask:0xf bank_mask:0xf bound_ctrl:1
    v_mov_b32_dpp v101, v93 row_shr:1 row_mask:0xf bank_mask:0xf bound_ctrl:1
    v_mov_b32_dpp v102, v94 row_shr:1 row_mask:0xf bank_mask:0xf bound_ctrl:1
    v_mov_b32_dpp v103, v95 row_shr:1 row_mask:0xf bank_mask:0xf bound_ctrl:1
    v_pk_add_f16 v92, v92, v100
    v_pk_add_f16 v93, v93, v101
    v_pk_add_f16 v94, v94, v102
    v_pk_add_f16 v95, v95, v103
    v_mov_b32_dpp v100, v96 row_shr:1 row_mask:0xf bank_mask:0xf bound_ctrl:1
    v_mov_b32_dpp v101, v97 row_shr:1 row_mask:0xf bank_mask:0xf bound_ctrl:1
    v_mov_b32_dpp v102, v98 row_shr:1 row_mask:0xf bank_mask:0xf bound_ctrl:1
    v_mov_b32_dpp v103, v99 row_shr:1 row_mask:0xf bank_mask:0xf bound_ctrl:1
    v_pk_add_f16 v96, v96, v100
    v_pk_add_f16 v97, v97, v101
    v_pk_add_f16 v98, v98, v102
    v_pk_add_f16 v99, v99, v103
    v_mov_b32_dpp v100, v92 row_shr:2 row_mask:0xf bank_mask:0xf bound_ctrl:1
    v_mov_b32_dpp v101, v93 row_shr:2 row_mask:0xf bank_mask:0xf bound_ctrl:1
    v_mov_b32_dpp v102, v94 row_shr:2 row_mask:0xf bank_mask:0xf bound_ctrl:1
    v_mov_b32_dpp v103, v95 row_shr:2 row_mask:0xf bank_mask:0xf bound_ctrl:1
    v_pk_add_f16 v92, v92, v100
    v_pk_add_f16 v93, v93, v101
    v_pk_add_f16 v94, v94, v102
    v_pk_add_f16 v95, v95, v103
    v_mov_b32_dpp v100, v96 row_shr:2 row_mask:0xf bank_mask:0xf bound_ctrl:1
    v_mov_b32_dpp v101, v97 row_shr:2 row_mask:0xf bank_mask:0xf bound_ctrl:1
    v_mov_b32_dpp v102, v98 row_shr:2 row_mask:0xf bank_mask:0xf bound_ctrl:1
    v_mov_b32_dpp v103, v99 row_shr:2 row_mask:0xf bank_mask:0xf bound_ctrl:1
    v_pk_add_f16 v96, v96, v100
    v_pk_add_f16 v97, v97, v101
    v_pk_add_f16 v98, v98, v102
    v_pk_add_f16 v99, v99, v103
    v_mov_b32_dpp v100, v92 row_shr:4 row_mask:0xf bank_mask:0xf bound_ctrl:1
    v_mov_b32_dpp v101, v93 row_shr:4 row_mask:0xf bank_mask:0xf bound_ctrl:1
    v_mov_b32_dpp v102, v94 row_shr:4 row_mask:0xf bank_mask:0xf bound_ctrl:1
    v_mov_b32_dpp v103, v95 row_shr:4 row_mask:0xf bank_mask:0xf bound_ctrl:1
    v_pk_add_f16 v92, v92, v100
    v_pk_add_f16 v93, v93, v101
    v_pk_add_f16 v94, v94, v102
    v_pk_add_f16 v95, v95, v103
    v_mov_b32_dpp v100, v96 row_shr:4 row_mask:0xf bank_mask:0xf bound_ctrl:1
    v_mov_b32_dpp v101, v97 row_shr:4 row_mask:0xf bank_mask:0xf bound_ctrl:1
    v_mov_b32_dpp v102, v98 row_shr:4 row_mask:0xf bank_mask:0xf bound_ctrl:1
    v_mov_b32_dpp v103, v99 row_shr:4 row_mask:0xf bank_mask:0xf bound_ctrl:1
    v_pk_add_f16 v96, v96, v100
    v_pk_add_f16 v97, v97, v101
    v_pk_add_f16 v98, v98, v102
    v_pk_add_f16 v99, v99, v103
    v_mov_b32_dpp v100, v92 row_shr:8 row_mask:0xf bank_mask:0xf bound_ctrl:1
    v_mov_b32_dpp v101, v93 row_shr:8 row_mask:0xf bank_mask:0xf bound_ctrl:1
    v_mov_b32_dpp v102, v94 row_shr:8 row_mask:0xf bank_mask:0xf bound_ctrl:1
    v_mov_b32_dpp v103, v95 row_shr:8 row_mask:0xf bank_mask:0xf bound_ctrl:1
    v_pk_add_f16 v92, v92, v100
    v_pk_add_f16 v93, v93, v101
    v_pk_add_f16 v94, v94, v102
    v_pk_add_f16 v95, v95, v103
    v_mov_b32_dpp v100, v96 row_shr:8 row_mask:0xf bank_mask:0xf bound_ctrl:1
    v_mov_b32_dpp v101, v97 row_shr:8 row_mask:0xf bank_mask:0xf bound_ctrl:1
    v_mov_b32_dpp v102, v98 row_shr:8 row_mask:0xf bank_mask:0xf bound_ctrl:1
    v_mov_b32_dpp v103, v99 row_shr:8 row_mask:0xf bank_mask:0xf bound_ctrl:1
    v_pk_add_f16 v96, v96, v100
    v_pk_add_f16 v97, v97, v101
    v_pk_add_f16 v98, v98, v102
    v_pk_add_f16 v99, v99, v103
    v_mov_b32_dpp v100, v92 row_bcast:15 row_mask:0xa bank_mask:0xf
    v_mov_b32_dpp v101, v93 row_bcast:15 row_mask:0xa bank_mask:0xf
    v_mov_b32_dpp v102, v94 row_bcast:15 row_mask:0xa bank_mask:0xf
    v_mov_b32_dpp v103, v95 row_bcast:15 row_mask:0xa bank_mask:0xf
    v_pk_add_f16 v92, v92, v100
    v_pk_add_f16 v93, v93, v101
    v_pk_add_f16 v94, v94, v102
    v_pk_add_f16 v95, v95, v103
    v_mov_b32_dpp v100, v96 row_bcast:15 row_mask:0xa bank_mask:0xf
    v_mov_b32_dpp v101, v97 row_bcast:15 row_mask:0xa bank_mask:0xf
    v_mov_b32_dpp v102, v98 row_bcast:15 row_mask:0xa bank_mask:0xf
    v_mov_b32_dpp v103, v99 row_bcast:15 row_mask:0xa bank_mask:0xf
    v_pk_add_f16 v96, v96, v100
    v_pk_add_f16 v97, v97, v101
    v_pk_add_f16 v98, v98, v102
    v_pk_add_f16 v99, v99, v103
    v_mov_b32_dpp v100, v92 row_bcast:31 row_mask:0xc bank_mask:0xf
    v_mov_b32_dpp v101, v93 row_bcast:31 row_mask:0xc bank_mask:0xf
    v_mov_b32_dpp v102, v94 row_bcast:31 row_mask:0xc bank_mask:0xf
    v_mov_b32_dpp v103, v95 row_bcast:31 row_mask:0xc bank_mask:0xf
    v_pk_add_f16 v92, v92, v100
    v_pk_add_f16 v93, v93, v101
    v_pk_add_f16 v94, v94, v102
    v_pk_add_f16 v95, v95, v103
    v_mov_b32_dpp v100, v96 row_bcast:31 row_mask:0xc bank_mask:0xf
    v_mov_b32_dpp v101, v97 row_bcast:31 row_mask:0xc bank_mask:0xf
    v_mov_b32_dpp v102, v98 row_bcast:31 row_mask:0xc bank_mask:0xf
    v_mov_b32_dpp v103, v99 row_bcast:31 row_mask:0xc bank_mask:0xf
    v_pk_add_f16 v96, v96, v100
    v_pk_add_f16 v97, v97, v101
    v_pk_add_f16 v98, v98, v102
    v_pk_add_f16 v99, v99, v103
    v_readlane_b32 s24, v92, 63
    v_readlane_b32 s25, v93, 63
    v_readlane_b32 s26, v94, 63
    v_readlane_b32 s27, v95, 63
    v_readlane_b32 s28, v96, 63
    v_readlane_b32 s29, v97, 63
    v_readlane_b32 s30, v98, 63
    v_readlane_b32 s31, v99, 63
    s_andn2_b64 s[46:47], s[46:47], s[54:55]
    s_ff1_i32_b64 s39, s[54:55]
    s_lshl_b64 exec, 1, s39
    s_or_b64 s[46:47], s[46:47], exec
    v_mov_b32 v104, s24
    v_mov_b32 v105, s25
    v_mov_b32 v106, s26
    v_mov_b32 v107, s27
    v_mov_b32 v108, s28
    v_mov_b32 v109, s29
    v_mov_b32 v110, s30
    v_mov_b32 v111, s31
    s_branch B_drain
B_codeend:
    s_endpgm
.section .rodata,"a"
.p2align 6
.amdhsa_kernel part_kernel
  .amdhsa_next_free_vgpr 128
  .amdhsa_next_free_sgpr 102
  .amdhsa_accum_offset 128
  .amdhsa_group_segment_fixed_size 0
  .amdhsa_kernarg_size 112
  .amdhsa_user_sgpr_count 2
  .amdhsa_user_sgpr_kernarg_segment_ptr 1
  .amdhsa_system_sgpr_workgroup_id_x 1
  .amdhsa_float_denorm_mode_32 3
.end_amdhsa_kernel
.section .rodata,"a"
.p2align 6
.amdhsa_kernel accum_kernel
  .amdhsa_next_free_vgpr 128
  .amdhsa_next_free_sgpr 102
  .amdhsa_accum_offset 128
  .amdhsa_group_segment_fixed_size 0
  .amdhsa_kernarg_size 112
  .amdhsa_user_sgpr_count 2
  .amdhsa_user_sgpr_kernarg_segment_ptr 1
  .amdhsa_system_sgpr_workgroup_id_x 1
  .amdhsa_float_denorm_mode_32 3
.end_amdhsa_kernel
```
